```python
import torch

def _softmax(x, axis=-1):
    return torch.softmax(x, dim=axis)
def _gelu(x):
    return torch.nn.functional.gelu(x, approximate="tanh")
def _silu(x):
    return torch.nn.functional.silu(x)
def _sigmoid(x):
    return torch.sigmoid(x)
def _layernorm(x, axis=-1, eps=1e-5):
    m = x.mean(dim=axis, keepdim=True)
    v = x.var(dim=axis, keepdim=True, unbiased=False)
    return (x - m) / torch.sqrt(v + eps)
def _scatter_add(tgt, idx, src, axis=0):
    return tgt.clone().index_add_(axis, idx, src)
def _segment_sum(src, seg, n):
    out = torch.zeros((n,) + src.shape[1:], dtype=src.dtype)
    return out.index_add_(0, seg, src)
def _pad(x, pw):
    flat = tuple(v for pair in reversed(pw) for v in pair)
    return torch.nn.functional.pad(x, flat)

kernel_name = 'sequential_preLN__ssm_conv_s4d__mixer_channel_mlp__prompt'

def setup_inputs():

    _w = (lambda a: (lambda t: t.to(torch.bfloat16) if t.is_floating_point() else t)(torch.as_tensor(a)))
    def _A_setup():
        Bsz, L, D, N = 1, 2048, 512, 128
        return {
            "u": _w((lambda *s: torch.randn(*s, dtype=torch.bfloat16) * 0.05)(Bsz, L, D)),
            "log_A_real": _w((lambda *s: torch.randn(*s, dtype=torch.bfloat16) * 3.2)(D, N) * 0.5),
            "A_imag": _w((lambda *s: torch.randn(*s, dtype=torch.bfloat16) * 0.05)(D, N) * 3.14),
            "C_real": _w((lambda *s: torch.randn(*s, dtype=torch.bfloat16) * 0.1)(D, N) / N ** 0.5),
            "C_imag": _w((lambda *s: torch.randn(*s, dtype=torch.bfloat16) * 0.1)(D, N) / N ** 0.5),
            "log_dt": _w((lambda *s: torch.randn(*s, dtype=torch.bfloat16) * 0.05)(D) * 0.5 - 4.0),
            "D_skip": _w((lambda *s: torch.randn(*s, dtype=torch.bfloat16) * 0.05)(D)),
        }
    _A_in = _A_setup()

    def _B_setup():
        B, S, D, F = 1, 2048, 512, 1792
        return {
            "x": _w((lambda *s: torch.randn(*s, dtype=torch.bfloat16) * 0.05)(B, S, D)),
            "w1": _w((lambda *s: torch.randn(*s, dtype=torch.bfloat16) * 1.6)(D, F) * (D ** -0.5)),
            "b1": _w((lambda *s: torch.randn(*s, dtype=torch.bfloat16) * 0.8)(F)),
            "w2": _w((lambda *s: torch.randn(*s, dtype=torch.bfloat16) * 0.05)(F, D) * (F ** -0.5)),
            "b2": _w((lambda *s: torch.randn(*s, dtype=torch.bfloat16) * 0.05)(D)),
        }
    _B_in = _B_setup()

    return {
        "A_u": _A_in["u"],
        "A_log_A_real": _A_in["log_A_real"],
        "A_A_imag": _A_in["A_imag"],
        "A_C_real": _A_in["C_real"],
        "A_C_imag": _A_in["C_imag"],
        "A_log_dt": _A_in["log_dt"],
        "A_D_skip": _A_in["D_skip"],
        "B_x": _B_in["x"],
        "B_w1": _B_in["w1"],
        "B_b1": _B_in["b1"],
        "B_w2": _B_in["w2"],
        "B_b2": _B_in["b2"],
    }

def reference(A_u, A_log_A_real, A_A_imag, A_C_real, A_C_imag, A_log_dt, A_D_skip, B_x, B_w1, B_b1, B_w2, B_b2):
    def _A_ref(u, log_A_real, A_imag, C_real, C_imag, log_dt, D_skip):
        L = u.shape[1]
        dt = torch.exp(log_dt)
        A = -torch.exp(log_A_real) + 1j * A_imag
        C = (C_real + 1j * C_imag) * dt[:, None]
        pos = (lambda x, dt: x.to(dt))(torch.arange(L), log_dt.dtype)
        P = torch.exp((A * dt[:, None])[:, :, None] * pos[None, None, :])
        K = 2.0 * torch.einsum("dn,dnl->dl", C, P).real
        L2 = 2 * L
        u_t = (lambda x, *d: x.permute(*d))(u, 0, 2, 1)
        Kf = (lambda x, *a, **k: torch.fft.rfft(x.float(), *a, **k))(K, L2)
        Uf = (lambda x, *a, **k: torch.fft.rfft(x.float(), *a, **k))(u_t, L2)
        y = (lambda x, *a, **k: torch.fft.irfft(x, *a, **k).to(torch.bfloat16))(Uf * Kf[None, :, :], L2)[:, :, :L]
        y = (lambda x, *d: x.permute(*d))(y, 0, 2, 1)
        return y + u * D_skip[None, None, :]

    def _B_ref(x, w1, b1, w2, b2):
        y = _layernorm(x, axis=-1)
        h = _gelu(torch.einsum("bsd,df->bsf", y, w1) + b1)
        return torch.einsum("bsf,fd->bsd", h, w2) + b2

    x = A_u
    h = x + _A_ref(_layernorm(x, axis=-1), A_log_A_real, A_A_imag, A_C_real, A_C_imag, A_log_dt, A_D_skip)
    h2 = h + _B_ref(_layernorm(h, axis=-1), B_w1, B_b1, B_w2, B_b2)
    return h2
```

```asm
; @launch grid=(256,1,1) block=(512,1,1) lds=163840
.amdgcn_target "amdgcn-amd-amdhsa--gfx950"
.text
    .text
    .p2align 12
.globl sequential_preLN__ssm_conv_s4d__mixer_channel_mlp__prompt_kernel
.p2align 8
.type sequential_preLN__ssm_conv_s4d__mixer_channel_mlp__prompt_kernel,@function
sequential_preLN__ssm_conv_s4d__mixer_channel_mlp__prompt_kernel:
    s_cmp_lt_u32 s2, 256
    s_cbranch_scc1 L_go
    s_endpgm
L_go:
    s_load_dwordx16 s[36:51], s[0:1], 0
    s_load_dwordx2 s[4:5], s[0:1], 112
    s_load_dwordx8 s[52:59], s[0:1], 64
    s_load_dwordx2 s[20:21], s[0:1], 96
    s_getpc_b64 s[68:69]
L_pc:
    s_and_b32 s64, s2, 0xf8
    v_lshrrev_b32 v4, 6, v0
    v_add_lshl_u32 v5, v4, s64, 7
    v_min_u32 v5, L_code_end-L_pc-4, v5
    global_load_dword v5, v5, s[68:69]
    v_readfirstlane_b32 s67, v4
    v_and_b32 v1, 63, v0
    v_and_b32 v0, 255, v0
    s_and_b32 s25, s2, 7
    s_lshr_b32 s26, s2, 3
    s_lshl_b32 s3, s25, 5
    s_add_u32 s3, s3, s26
    s_and_b32 s24, s67, 3
    s_and_b32 s65, s2, 0x80
    s_and_b32 s66, s2, 63
    s_lshl1_add_u32 s65, s66, s65
    s_bfe_u32 s66, s2, 0x10006
    s_lshl2_add_u32 s65, s65, s66
    s_lshl_b32 s65, s65, 11
    v_and_b32 v6, 3, v1
    v_lshrrev_b32 v7, 2, v0
    v_lshl_add_u32 v8, v6, 12, s65
    v_lshl_add_u32 v8, v7, 4, v8
    s_and_b32 s29, s24, 1
    s_lshr_b32 s30, s24, 1
    s_lshl1_add_u32 s66, s3, s29
    s_lshl1_add_u32 s66, s66, s30
    s_lshl_b32 s66, s66, 7
    v_lshl_add_u32 v30, v1, 1, s66
    s_lshl_b32 s66, s3, 2
    v_lshlrev_b32 v9, 2, v1
    v_mov_b32 v10, 0
    v_mov_b32 v11, -1
    ds_write_b32 v9, v11 offset:42496
    v_and_b32 v9, 0x7c, v9
    v_add_u32 v9, 163712, v9
    ds_write_b32 v9, v10
    s_cmp_ge_u32 s67, 4
    s_waitcnt lgkmcnt(0)
    s_cbranch_scc1 L_H
    global_load_ushort v26, v30, s[38:39]
    global_load_ushort v27, v30, s[40:41]
    global_load_ushort v28, v30, s[42:43]
    global_load_ushort v29, v30, s[44:45]
    s_load_dword s61, s[46:47], s66
    s_load_dword s62, s[48:49], s66
    s_load_dword s27, s[4:5], 0x0
    s_barrier
    s_branch L_M
L_H:
    global_load_dwordx4 v[128:131], v8, s[36:37] offset:0
    global_load_dwordx4 v[132:135], v8, s[36:37] offset:1024
    s_load_dword s27, s[4:5], 0x0
    s_barrier
    s_mov_b32 s6, 0x10000000
    s_mov_b32 s7, 0x20000
    s_mov_b32 s14, 0x1c0000
    s_mov_b32 s15, 0x20000
    s_mov_b32 s18, 0x1c0000
    s_mov_b32 s19, 0x20000
    s_mov_b32 s22, 0x200000
    s_mov_b32 s23, 0x20000
    s_mov_b32 s28, 0x40000
    s_lshr_b32 s64, s26, 2
    s_add_u32 s32, s64, s26
    s_and_b32 s32, s32, 3
    s_and_b32 s65, s25, 1
    s_lshl_b32 s65, s65, 3
    s_add_u32 s64, s64, s65
    s_lshl_b32 s64, s64, 2
    s_add_u32 s60, s64, s24
    s_lshr_b32 s35, s25, 1
    s_and_b32 s63, s26, 3
    s_lshl_b32 s64, s35, 2
    s_add_u32 s33, s64, s63
    s_lshl_b32 s34, s24, 10
    s_lshl_b32 s66, s60, 4
    s_add_u32 s64, s66, s33
    s_mul_i32 s31, s64, 7168
    s_add_u32 s31, s31, 0x340000
    s_mov_b64 s[12:13], s[52:53]
    s_mov_b64 s[16:17], s[56:57]
    s_lshl2_add_u32 s64, s26, s24
    s_lshl4_add_u32 s64, s64, s35
    s_mul_i32 s64, s64, 896
    v_min_u32 v22, 27, v1
    v_mul_u32_u24 v23, 37, v22
    v_lshrrev_b32 v23, 8, v23
    v_mul_u32_u24 v23, 2688, v23
    v_lshl_add_u32 v23, v22, 7, v23
    v_add_u32 v23, s64, v23
    s_lshr_b32 s64, s2, 6
    s_bfe_u32 s65, s2, 0x10003
    s_lshl1_add_u32 s64, s64, s65
    s_and_b32 s65, s2, 1
    s_lshl1_add_u32 s64, s64, s65
    s_bfe_u32 s65, s2, 0x20004
    s_lshl2_add_u32 s66, s35, s65
    s_lshl4_add_u32 s66, s66, s64
    s_lshl_b32 s66, s66, 6
    s_add_u32 s45, s66, 0x8000
    s_lshl2_add_u32 s64, s64, s65
    s_mul_i32 s65, s64, 28672
    s_mul_i32 s66, s35, 896
    s_add_u32 s65, s65, s66
    s_lshl_b32 s66, s35, 6
    s_add_u32 s64, s64, s66
    s_mul_i32 s64, s64, 768
    s_add_u32 s44, s64, 0x40000
    s_cmp_eq_u32 s24, 0
    s_cselect_b32 s64, 47, 0
    v_min_u32 v24, s64, v1
    v_mul_u32_u24 v25, 43, v24
    v_lshrrev_b32 v25, 8, v25
    v_mul_u32_u24 v25, 2816, v25
    v_and_b32 v22, 62, v24
    v_mul_u32_u24 v22, 112, v22
    v_lshlrev_b32 v24, 4, v24
    v_add3_u32 v25, v25, v22, v24
    buffer_load_dwordx4 v[152:155], v25, s[12:15], s65 offen offset:224
    v_lshlrev_b32 v2, 4, v0
    v_lshlrev_b32 v3, 4, v1
    v_lshrrev_b32 v9, 3, v0
    v_and_b32 v59, 0x70, v3
    v_lshl_add_u32 v60, v9, 15, v59
    v_lshl_add_u32 v59, v9, 10, v59
    s_and_b32 s68, s2, 63
    s_lshl_b32 s68, s68, 15
    s_and_b32 s64, s2, 0xc0
    s_lshl1_add_u32 s68, s64, s68
    s_add_u32 s68, s68, 0x100000
    s_lshl_b32 s69, s2, 6
    s_add_u32 s69, s69, 0x4000
    s_and_b32 s64, s3, 0xf8
    s_and_b32 s65, s3, 2
    s_lshl1_add_u32 s64, s65, s64
    s_and_b32 s65, s3, 4
    s_lshl3_add_u32 s64, s64, s65
    s_and_b32 s65, s3, 1
    s_lshl1_add_u32 s64, s64, s65
    s_lshl3_add_u32 s40, s64, 0x100000
    s_lshl_b32 s3, s3, 7
    s_add_u32 s3, s3, 0x100000
    s_add_u32 s46, s3, 0x100000
    s_add_u32 s47, s3, 0x200000
    v_lshlrev_b32 v15, 6, v6
    v_lshrrev_b32 v4, 4, v1
    s_lshl_b32 s64, s24, 4
    v_lshl_add_u32 v4, v4, 2, s64
    v_add_u32 v4, v4, v15
    v_mov_b32 v11, 0
    v_mov_b32 v12, 0
    v_mov_b32 v13, 0
    v_mov_b32 v14, 0x3f803f80
    v_mul_u32_u24 v6, 6, v6
    v_add_u32 v7, 3, v6
    v_mov_b32 v16, 0x3b000000
    v_mov_b32 v17, 0x3f000000
    v_mov_b32 v18, 0x43000000
    v_mov_b32 v19, 0x3f27c5ac
    v_mov_b32 v20, 0x3c000000
    s_mov_b32 s49, 0x70007000
    s_waitcnt lgkmcnt(0)
    s_add_u32 s27, s27, 0x1739b9
    s_or_b32 s27, s27, 0xffc00000
    s_and_b32 s64, s27, 0x7000
    s_mov_b32 s52, 0x70000000
    v_bfe_u32 v34, s27, v6, 3
    v_bfe_u32 v35, s27, v7, 3
    v_lshl_or_b32 v34, v34, 28, s64
    v_lshl_or_b32 v35, v35, 12, s52
    v_mov_b32 v67, s27
    v_mov_b32 v68, s27
    v_mov_b32 v69, s27
    v_mov_b32 v70, s27
    v_mov_b32 v71, s27
    s_setprio 2
    s_waitcnt vmcnt(2)
    v_dot2c_f32_bf16 v10, v128, v14
    v_dot2c_f32_bf16 v12, v128, v128
    v_dot2c_f32_bf16 v10, v129, v14
    v_dot2c_f32_bf16 v12, v129, v129
    v_dot2c_f32_bf16 v10, v130, v14
    v_dot2c_f32_bf16 v12, v130, v130
    v_dot2c_f32_bf16 v10, v131, v14
    v_dot2c_f32_bf16 v12, v131, v131
    s_waitcnt vmcnt(1)
    v_dot2c_f32_bf16 v11, v132, v14
    v_dot2c_f32_bf16 v13, v132, v132
    v_dot2c_f32_bf16 v11, v133, v14
    v_dot2c_f32_bf16 v13, v133, v133
    v_dot2c_f32_bf16 v11, v134, v14
    v_dot2c_f32_bf16 v13, v134, v134
    v_dot2c_f32_bf16 v11, v135, v14
    v_dot2c_f32_bf16 v13, v135, v135
    v_permlane32_swap_b32 v10, v12
    s_nop 1
    v_permlane32_swap_b32 v11, v13
    v_add_f32 v10, v10, v12
    v_add_f32 v11, v11, v13
    s_nop 1
    v_permlane16_swap_b32 v10, v11
    v_add_f32 v10, v10, v11
    s_nop 1
    v_add_f32_dpp v10, v10, v10 row_ror:8 row_mask:0xf bank_mask:0xf
    s_nop 1
    v_add_f32_dpp v10, v10, v10 row_ror:4 row_mask:0xf bank_mask:0xf
    ds_write_b32 v4, v10 offset:42496
    buffer_load_dword v159, v23, s[12:15], 0 offen
R_sx:
    ds_read_b128 v[136:139], v15 offset:42496
    ds_read_b128 v[140:143], v15 offset:42512
    ds_read_b128 v[144:147], v15 offset:42528
    ds_read_b128 v[148:151], v15 offset:42544
    v_lshlrev_b32 v96, 16, v128
    v_lshlrev_b32 v97, 16, v132
    v_and_b32 v98, 0xffff0000, v128
    v_and_b32 v99, 0xffff0000, v132
    v_lshlrev_b32 v100, 16, v129
    v_lshlrev_b32 v101, 16, v133
    v_and_b32 v102, 0xffff0000, v129
    v_and_b32 v103, 0xffff0000, v133
    v_lshlrev_b32 v104, 16, v130
    v_lshlrev_b32 v105, 16, v134
    v_and_b32 v106, 0xffff0000, v130
    v_and_b32 v107, 0xffff0000, v134
    v_lshlrev_b32 v108, 16, v131
    v_lshlrev_b32 v109, 16, v135
    v_and_b32 v110, 0xffff0000, v131
    v_and_b32 v111, 0xffff0000, v135
    s_waitcnt lgkmcnt(0)
    v_max3_u32 v10, v136, v139, v140
    v_max3_u32 v11, v143, v144, v147
    v_max3_u32 v10, v148, v151, v10
    v_max_u32 v10, v10, v11
    v_cmp_eq_u32 vcc, -1, v10
    s_cbranch_vccnz R_sx
B_sx:
    v_pk_add_f32 v[136:137], v[136:137], v[140:141]
    v_pk_add_f32 v[138:139], v[138:139], v[142:143]
    v_pk_add_f32 v[144:145], v[144:145], v[148:149]
    v_pk_add_f32 v[146:147], v[146:147], v[150:151]
    v_pk_add_f32 v[136:137], v[136:137], v[144:145]
    v_pk_add_f32 v[138:139], v[138:139], v[146:147]
    v_pk_mul_f32 v[140:141], v[136:137], v[16:17] op_sel:[0,1] op_sel_hi:[1,1]
    v_pk_fma_f32 v[138:139], v[138:139], v[18:19], v[18:19] op_sel:[0,0,1] op_sel_hi:[1,0,1]
    v_pk_mul_f32 v[136:137], v[136:137], v[16:17] op_sel_hi:[1,0]
    v_pk_fma_f32 v[138:139], v[140:141], v[140:141], v[138:139] neg_lo:[1,0,0] neg_hi:[1,0,0]
    v_cvt_pk_bf16_f32 v66, v136, v137
    v_max_f32 v138, v138, v19
    v_max_f32 v139, v139, v19
    v_rsq_f32 v140, v138
    v_rsq_f32 v141, v139
    v_lshlrev_b32 v136, 16, v66
    v_and_b32 v137, 0xffff0000, v66
    v_pk_fma_f32 v[136:137], v[136:137], v[140:141], v[20:21] op_sel_hi:[1,1,0] neg_lo:[1,0,0] neg_hi:[1,0,0]
    v_pk_fma_f32 v[96:97], v[96:97], v[140:141], v[136:137]
    v_pk_fma_f32 v[98:99], v[98:99], v[140:141], v[136:137]
    v_pk_fma_f32 v[100:101], v[100:101], v[140:141], v[136:137]
    v_pk_fma_f32 v[102:103], v[102:103], v[140:141], v[136:137]
    v_pk_add_f32 v[96:97], v[96:97], v[20:21] op_sel_hi:[1,0] neg_lo:[0,1] neg_hi:[0,1]
    v_pk_add_f32 v[98:99], v[98:99], v[20:21] op_sel_hi:[1,0] neg_lo:[0,1] neg_hi:[0,1]
    v_pk_add_f32 v[100:101], v[100:101], v[20:21] op_sel_hi:[1,0] neg_lo:[0,1] neg_hi:[0,1]
    v_pk_add_f32 v[102:103], v[102:103], v[20:21] op_sel_hi:[1,0] neg_lo:[0,1] neg_hi:[0,1]
    v_cvt_pk_bf16_f32 v112, v96, v97
    v_cvt_pk_bf16_f32 v113, v98, v99
    v_cvt_pk_bf16_f32 v114, v100, v101
    v_cvt_pk_bf16_f32 v115, v102, v103
    v_bfi_b32 v112, s49, v34, v112
    v_bfi_b32 v113, s49, v35, v113
    v_bfi_b32 v114, s49, v34, v114
    v_bfi_b32 v115, s49, v35, v115
    buffer_store_dwordx4 v[112:115], v59, s[4:7], s68 offen offset:0 sc1
    v_pk_fma_f32 v[104:105], v[104:105], v[140:141], v[136:137]
    v_pk_fma_f32 v[106:107], v[106:107], v[140:141], v[136:137]
    v_pk_fma_f32 v[108:109], v[108:109], v[140:141], v[136:137]
    v_pk_fma_f32 v[110:111], v[110:111], v[140:141], v[136:137]
    v_pk_add_f32 v[104:105], v[104:105], v[20:21] op_sel_hi:[1,0] neg_lo:[0,1] neg_hi:[0,1]
    v_pk_add_f32 v[106:107], v[106:107], v[20:21] op_sel_hi:[1,0] neg_lo:[0,1] neg_hi:[0,1]
    v_pk_add_f32 v[108:109], v[108:109], v[20:21] op_sel_hi:[1,0] neg_lo:[0,1] neg_hi:[0,1]
    v_pk_add_f32 v[110:111], v[110:111], v[20:21] op_sel_hi:[1,0] neg_lo:[0,1] neg_hi:[0,1]
    v_cvt_pk_bf16_f32 v116, v104, v105
    v_cvt_pk_bf16_f32 v117, v106, v107
    v_cvt_pk_bf16_f32 v118, v108, v109
    v_cvt_pk_bf16_f32 v119, v110, v111
    v_bfi_b32 v116, s49, v34, v116
    v_bfi_b32 v117, s49, v35, v117
    v_bfi_b32 v118, s49, v34, v118
    v_bfi_b32 v119, s49, v35, v119
    buffer_store_dwordx4 v[116:119], v59, s[4:7], s68 offen offset:512 sc1
    s_cmp_lg_u32 s24, 0
    s_cbranch_scc1 L_H_c2
    v_pk_mul_f32 v[64:65], v[138:139], v[140:141]
    buffer_store_dwordx4 v[68:71], v60, s[4:7], s47 offen sc1
    s_waitcnt vmcnt(4)
    buffer_store_dwordx4 v[152:155], v24, s[4:7], s44 offen sc1
L_H_c2:
    s_setprio 0
    v_and_b32 v21, 0x30, v2
    v_lshrrev_b32 v9, 2, v0
    v_lshl_add_u32 v21, v9, 15, v21
    v_xor_b32 v36, 0x30003000, v34
    v_xor_b32 v37, 0x30003000, v35
    s_lshl_b32 s64, s24, 2
    s_add_u32 s64, s64, 163712
    v_mov_b32 v91, s64
    v_mov_b32 v92, 163712
    v_mov_b32 v44, 0
    v_mov_b32 v45, 0
    v_mov_b32 v46, 0
    v_mov_b32 v47, 0
    v_lshrrev_b32 v8, 5, v1
    v_and_b32 v9, 31, v1
    v_min_u32 v9, 29, v9
    s_movk_i32 s67, 4576
    v_lshlrev_b32 v9, 4, v9
    v_mad_u32_u24 v8, v8, s67, v9
    ds_write_b128 v8, v[44:47] offset:33280
    v_lshrrev_b32 v8, 2, v1
    v_and_b32 v9, 3, v1
    v_lshl_add_u32 v8, v9, 2, v8
    v_and_b32 v8, 15, v8
    v_lshl_add_u32 v8, v9, 4, v8
    v_lshl_add_u32 v61, v8, 4, s34
    v_add_u32 v93, 0x1000, v2
    v_add_u32 v94, 0x2000, v2
    v_add_u32 v95, 0x3000, v2
    v_add_u32 v63, 0x1000, v3
    v_lshlrev_b32 v8, 3, v0
    s_cmp_eq_u32 s24, 0
    s_cbranch_scc1 S_0
    s_cmp_eq_u32 s24, 1
    s_cbranch_scc1 S_1
    s_cmp_eq_u32 s24, 2
    s_cbranch_scc1 S_2
    s_branch S_3
S_back:
    s_cmp_eq_u32 s24, 0
    s_cselect_b32 s64, 4, 0
    v_mov_b32 v164, 0x10000000
    v_cmp_gt_u32 vcc, s64, v1
    s_nop 1
    v_cndmask_b32 v163, v164, v3, vcc
    s_waitcnt vmcnt(0)
    buffer_store_dwordx4 v[68:71], v163, s[4:7], s45 offen sc1
    ds_read_b128 v[128:131], v92 offset:80
    s_waitcnt lgkmcnt(0)
    v_min3_u32 v128, v128, v129, v130
    v_min_u32 v128, v128, v131
    v_cmp_eq_u32 vcc, 0, v128
    s_cbranch_vccnz R_ft
B_ft:
    buffer_load_dwordx2 v[96:97], v21, s[4:7], s40 offen offset:0 sc1
    buffer_load_dwordx2 v[98:99], v21, s[4:7], s40 offen offset:128 sc1
    buffer_load_dwordx2 v[100:101], v21, s[4:7], s40 offen offset:256 sc1
    buffer_load_dwordx2 v[102:103], v21, s[4:7], s40 offen offset:384 sc1
    s_mul_i32 s66, s35, 896
    s_lshl_b32 s65, s63, 8
    s_add_u32 s66, s66, s65
    s_mul_i32 s65, s24, 28672
    s_add_u32 s66, s66, s65
    s_mul_i32 s50, s24, 768
    s_mul_i32 s67, s35, 49152
    s_add_u32 s67, s67, s50
    s_add_u32 s67, s67, 0x40000
    s_add_u32 s65, s66, 128
    s_movk_i32 s62, 3584
    s_cmp_eq_u32 s63, 3
    s_cselect_b32 s67, s67, s65
    s_cmov_b32 s62, 96
    s_cselect_b64 s[20:21], s[4:5], s[12:13]
    s_cselect_b32 s22, s6, s14
    s_lshr_b32 s65, s26, 2
    s_lshl_b32 s61, s62, 5
    s_add_u32 s64, s65, 0
    s_and_b32 s64, s64, 3
    s_mul_i32 s8, s64, 458752
    s_add_u32 s8, s8, s66
    s_mul_i32 s64, s64, s61
    s_lshl2_add_u32 s36, s64, s67
    s_add_u32 s64, s65, 1
    s_and_b32 s64, s64, 3
    s_mul_i32 s9, s64, 458752
    s_add_u32 s9, s9, s66
    s_mul_i32 s64, s64, s61
    s_lshl2_add_u32 s37, s64, s67
    s_add_u32 s64, s65, 2
    s_and_b32 s64, s64, 3
    s_mul_i32 s10, s64, 458752
    s_add_u32 s10, s10, s66
    s_mul_i32 s64, s64, s61
    s_lshl2_add_u32 s38, s64, s67
    s_add_u32 s64, s65, 3
    s_and_b32 s64, s64, 3
    s_mul_i32 s11, s64, 458752
    s_add_u32 s11, s11, s66
    s_mul_i32 s64, s64, s61
    s_lshl2_add_u32 s39, s64, s67
    v_lshrrev_b32 v22, 3, v1
    v_mul_u32_u24 v52, 3584, v22
    v_and_b32 v22, 6, v22
    v_xor_b32 v22, v22, v1
    v_and_b32 v22, 7, v22
    v_lshl_add_u32 v52, v22, 4, v52
    v_min_u32 v53, 47, v1
    v_mul_u32_u24 v22, 43, v53
    v_lshrrev_b32 v22, 8, v22
    s_sub_u32 s64, s62, 96
    v_mul_u32_u24 v22, s64, v22
    v_lshl_add_u32 v53, v53, 4, v22
    s_add_u32 s64, s50, 47872
    v_lshl_add_u32 v54, v1, 4, s64
    v_add_u32 v55, 102400, v54
    s_mul_i32 s66, s35, 896
    s_lshl_b32 s65, s63, 8
    s_add_u32 s66, s66, s65
    v_min_u32 v38, 55, v1
    v_lshrrev_b32 v39, 3, v38
    v_lshl_add_u32 v38, v38, 2, s66
    s_cmp_eq_u32 s63, 3
    s_cselect_b32 s65, 224, 0
    v_sub_u32 v40, 7, v39
    v_mul_u32_u24 v40, s65, v40
    v_cmp_lt_u32 vcc, 3, v39
    s_nop 1
    v_cndmask_b32 v40, 0, v40, vcc
    v_sub_u32 v38, v38, v40
    s_lshl_b32 s64, s32, 2
    s_add_u32 s64, s64, s35
    s_lshl_b32 s64, s64, 6
    v_and_b32 v39, 15, v1
    v_lshl_add_u32 v39, v39, 2, s64
    v_lshrrev_b32 v40, 4, v1
    v_and_b32 v41, 3, v1
    v_bfe_u32 v49, v1, 2, 2
    v_xor_b32 v49, v49, v40
    v_xor_b32 v49, s35, v49
    v_lshlrev_b32 v49, 6, v49
    v_lshl_add_u32 v49, v41, 4, v49
    v_lshl_add_u32 v49, v40, 10, v49
    s_mul_i32 s66, s35, 458752
    s_lshl_b32 s65, s24, 12
    s_add_u32 s66, s66, s65
    s_lshl_b32 s65, s32, 8
    s_add_u32 s66, s66, s65
    s_xor_b32 s64, s63, 0
    s_mul_i32 s64, s64, 131072
    s_add_u32 s41, s64, s66
    s_xor_b32 s64, s63, 1
    s_mul_i32 s64, s64, 131072
    s_add_u32 s42, s64, s66
    s_xor_b32 s64, s63, 2
    s_mul_i32 s64, s64, 131072
    s_add_u32 s43, s64, s66
    s_xor_b32 s64, s63, 3
    s_mul_i32 s64, s64, 131072
    s_add_u32 s53, s64, s66
    s_lshl_b32 s64, s35, 5
    s_add_u32 s64, s64, s26
    s_lshl2_add_u32 s64, s64, s24
    s_mul_i32 s64, s64, 3584
    v_min_u32 v88, 27, v1
    v_lshl_add_u32 v88, v88, 7, s64
    s_lshl2_add_u32 s64, s35, s24
    s_lshl_b32 s64, s64, 10
    s_add_u32 s64, s64, 0x800c
    s_cmp_eq_u32 s63, 3
    s_cselect_b32 s64, s64, 0x10000000
    s_cselect_b32 s51, s27, 0
    v_and_b32 v62, 15, v1
    v_lshl_add_u32 v62, v62, 6, s64
    s_add_u32 m0, s34, 121600
    s_add_u32 s64, s10, 114688
    buffer_load_dwordx4 v52, s[12:15], s64 offen sc1 lds
    s_add_u32 m0, s34, 125696
    s_add_u32 s64, s10, 229376
    buffer_load_dwordx4 v52, s[12:15], s64 offen sc1 lds
    s_add_u32 m0, s34, 129792
    s_add_u32 s64, s10, 344064
    buffer_load_dwordx4 v52, s[12:15], s64 offen sc1 lds
    s_add_u32 m0, s34, 133888
    s_add_u32 s64, s11, 0
    buffer_load_dwordx4 v52, s[12:15], s64 offen sc1 lds
    s_add_u32 m0, s34, 137984
    s_add_u32 s64, s11, 114688
    buffer_load_dwordx4 v52, s[12:15], s64 offen sc1 lds
    s_add_u32 m0, s34, 142080
    s_add_u32 s64, s11, 229376
    buffer_load_dwordx4 v52, s[12:15], s64 offen sc1 lds
    s_add_u32 m0, s34, 146176
    s_add_u32 s64, s11, 344064
    buffer_load_dwordx4 v52, s[12:15], s64 offen sc1 lds
    s_setprio 2
    s_waitcnt vmcnt(7)
    v_xor_b32 v26, v36, v96
    v_xor_b32 v27, v36, v98
    v_xor_b32 v28, v37, v97
    v_xor_b32 v29, v37, v99
    v_xor_b32 v30, v36, v100
    v_xor_b32 v31, v36, v102
    v_xor_b32 v32, v37, v101
    v_xor_b32 v33, v37, v103
    ds_write_b64 v8, v[26:27] offset:33760
    ds_write_b64 v8, v[28:29] offset:38336
    ds_write_b64 v8, v[30:31] offset:35808
    ds_write_b64 v8, v[32:33] offset:40384
    v_bitop3_b32 v104, v96, v98, v34 bitop3:0x7e
    v_bitop3_b32 v105, v97, v99, v35 bitop3:0x7e
    v_bitop3_b32 v106, v100, v102, v34 bitop3:0x7e
    v_bitop3_b32 v107, v101, v103, v35 bitop3:0x7e
    v_or3_b32 v104, v104, v105, v106
    v_bitop3_b32 v104, v104, v107, s49 bitop3:0xa8
    v_cmp_ne_u32 vcc, 0, v104
    s_cbranch_vccnz R_g1
B_g1:
    s_waitcnt lgkmcnt(0)
    s_barrier
    s_cmp_lg_u32 s24, 0
    s_cbranch_scc1 L_H_nf
    s_mov_b64 exec, 15
    buffer_store_dwordx4 v[64:67], v3, s[4:7], s69 offen sc1
    s_mov_b64 exec, -1
L_H_nf:
    s_mov_b32 s69, 0x4000
    buffer_load_dword v89, v62, s[4:7], 0 offen sc1
    global_load_dword v38, v38, s[54:55]
    global_load_dword v39, v39, s[58:59]
    buffer_load_dword v88, v88, s[16:19], 0 offen
    s_add_u32 m0, s34, 84736
    s_add_u32 s64, s8, 0
    buffer_load_dwordx4 v52, s[12:15], s64 offen sc1 lds
    s_add_u32 m0, s34, 88832
    s_add_u32 s64, s8, 114688
    buffer_load_dwordx4 v52, s[12:15], s64 offen sc1 lds
    s_add_u32 m0, s34, 92928
    s_add_u32 s64, s8, 229376
    buffer_load_dwordx4 v52, s[12:15], s64 offen sc1 lds
    s_add_u32 m0, s34, 97024
    s_add_u32 s64, s8, 344064
    buffer_load_dwordx4 v52, s[12:15], s64 offen sc1 lds
    s_add_u32 m0, s34, 101120
    s_add_u32 s64, s9, 0
    buffer_load_dwordx4 v52, s[12:15], s64 offen sc1 lds
    s_add_u32 m0, s34, 105216
    s_add_u32 s64, s9, 114688
    buffer_load_dwordx4 v52, s[12:15], s64 offen sc1 lds
    s_add_u32 m0, s34, 109312
    s_add_u32 s64, s9, 229376
    buffer_load_dwordx4 v52, s[12:15], s64 offen sc1 lds
    s_add_u32 m0, s34, 113408
    s_add_u32 s64, s9, 344064
    buffer_load_dwordx4 v52, s[12:15], s64 offen sc1 lds
    s_add_u32 m0, s34, 117504
    s_add_u32 s64, s10, 0
    buffer_load_dwordx4 v52, s[12:15], s64 offen sc1 lds
    s_waitcnt vmcnt(12)
    v_cmp_ne_u32 vcc, s51, v89
    s_cbranch_vccnz R_rf
B_rf:
    buffer_load_dwordx4 v[252:255], v53, s[20:23], s36 offen sc1
    s_add_u32 s36, s36, s61
    buffer_load_dwordx4 v[248:251], v53, s[20:23], s36 offen sc1
    s_add_u32 s36, s36, s61
    buffer_load_dwordx4 v[244:247], v53, s[20:23], s36 offen sc1
    s_branch S_0o
S_0:
    s_branch S_back
S_0o:
    s_add_u32 s36, s36, s61
    buffer_load_dwordx4 v[240:243], v53, s[20:23], s36 offen sc1
    buffer_load_dwordx4 v[236:239], v53, s[20:23], s37 offen sc1
    s_add_u32 s37, s37, s61
    buffer_load_dwordx4 v[232:235], v53, s[20:23], s37 offen sc1
    s_add_u32 s37, s37, s61
    buffer_load_dwordx4 v[228:231], v53, s[20:23], s37 offen sc1
    s_add_u32 s37, s37, s61
    buffer_load_dwordx4 v[224:227], v53, s[20:23], s37 offen sc1
    v_lshlrev_b32 v10, 16, v26
    v_and_b32 v11, 0xffff0000, v26
    v_lshlrev_b32 v14, 16, v28
    v_and_b32 v15, 0xffff0000, v28
    v_lshlrev_b32 v12, 16, v27
    v_and_b32 v13, 0xffff0000, v27
    v_lshlrev_b32 v16, 16, v29
    v_and_b32 v17, 0xffff0000, v29
    v_lshlrev_b32 v18, 16, v30
    v_and_b32 v19, 0xffff0000, v30
    v_lshlrev_b32 v22, 16, v32
    v_and_b32 v23, 0xffff0000, v32
    v_lshlrev_b32 v20, 16, v31
    v_and_b32 v21, 0xffff0000, v31
    v_lshlrev_b32 v24, 16, v33
    v_and_b32 v25, 0xffff0000, v33
    s_waitcnt vmcnt(18)
    v_lshlrev_b32 v6, 16, v38
    v_and_b32 v7, 0xffff0000, v38
    v_lshlrev_b32 v8, 3, v1
    v_add_u32 v8, 163072, v8
    v_lshlrev_b32 v38, 16, v39
    v_and_b32 v39, 0xffff0000, v39
    v_mul_f32 v6, 0x30800000, v6
    v_mul_f32 v7, 0x30800000, v7
    ds_write_b64 v8, v[6:7]
    s_mov_b64 exec, 0xffff
    ds_write_b64 v8, v[38:39] offset:512
    s_mov_b64 exec, -1
    buffer_load_dwordx4 v[112:115], v2, s[4:7], s69 offen sc1
    buffer_load_dwordx4 v[116:119], v93, s[4:7], s69 offen sc1
    buffer_load_dwordx4 v[120:123], v94, s[4:7], s69 offen sc1
    buffer_load_dwordx4 v[124:127], v95, s[4:7], s69 offen sc1
    buffer_load_dwordx4 v[220:223], v53, s[20:23], s38 offen sc1
    s_add_u32 s38, s38, s61
    buffer_load_dwordx4 v[216:219], v53, s[20:23], s38 offen sc1
    s_add_u32 s38, s38, s61
    buffer_load_dwordx4 v[212:215], v53, s[20:23], s38 offen sc1
    s_add_u32 s38, s38, s61
    buffer_load_dwordx4 v[208:211], v53, s[20:23], s38 offen sc1
    buffer_load_dwordx4 v[204:207], v53, s[20:23], s39 offen sc1
    s_add_u32 s39, s39, s61
    buffer_load_dwordx4 v[200:203], v53, s[20:23], s39 offen sc1
    s_add_u32 s39, s39, s61
    buffer_load_dwordx4 v[196:199], v53, s[20:23], s39 offen sc1
    s_add_u32 s39, s39, s61
    buffer_load_dwordx4 v[192:195], v53, s[20:23], s39 offen sc1
    s_waitcnt vmcnt(20)
    s_barrier
    ds_read_b128 v[128:131], v61 offset:0
    ds_read_b128 v[132:135], v61 offset:8192
    ds_read_b128 v[136:139], v61 offset:16640
    ds_read_b128 v[140:143], v61 offset:24832
    ds_read_b128 v[144:147], v61 offset:4096
    ds_read_b128 v[148:151], v61 offset:12288
    ds_read_b128 v[152:155], v61 offset:20736
    ds_read_b128 v[156:159], v61 offset:28928
    s_waitcnt vmcnt(8)
    v_min3_u32 v6, v115, v119, v123
    v_max3_u32 v7, v115, v119, v123
    v_min3_u32 v6, v127, v67, v6
    v_max3_u32 v7, v127, v67, v7
    v_cmp_ne_u32 vcc, v6, v7
    s_cbranch_vccnz R_s1
B_s1:
    v_lshlrev_b32 v6, 16, v114
    v_and_b32 v7, 0xffff0000, v114
    v_fma_f32 v10, v10, v112, v6
    v_fma_f32 v11, v11, v113, v7
    v_fma_f32 v14, v14, v112, v6
    v_fma_f32 v15, v15, v113, v7
    v_lshlrev_b32 v6, 16, v118
    v_and_b32 v7, 0xffff0000, v118
    v_fma_f32 v12, v12, v116, v6
    v_fma_f32 v13, v13, v117, v7
    v_fma_f32 v16, v16, v116, v6
    v_fma_f32 v17, v17, v117, v7
    v_lshlrev_b32 v6, 16, v122
    v_and_b32 v7, 0xffff0000, v122
    v_fma_f32 v18, v18, v120, v6
    v_fma_f32 v19, v19, v121, v7
    v_fma_f32 v22, v22, v120, v6
    v_fma_f32 v23, v23, v121, v7
    v_lshlrev_b32 v6, 16, v126
    v_and_b32 v7, 0xffff0000, v126
    v_fma_f32 v20, v20, v124, v6
    v_fma_f32 v21, v21, v125, v7
    v_fma_f32 v24, v24, v124, v6
    v_fma_f32 v25, v25, v125, v7
    s_waitcnt lgkmcnt(4)
    v_pk_add_f32 v[10:11], v[10:11], v[128:129]
    v_pk_add_f32 v[12:13], v[12:13], v[130:131]
    v_pk_add_f32 v[14:15], v[14:15], v[136:137]
    v_pk_add_f32 v[16:17], v[16:17], v[138:139]
    v_pk_add_f32 v[10:11], v[10:11], v[132:133]
    v_pk_add_f32 v[12:13], v[12:13], v[134:135]
    v_pk_add_f32 v[14:15], v[14:15], v[140:141]
    v_pk_add_f32 v[16:17], v[16:17], v[142:143]
    v_cvt_pk_bf16_f32 v28, v10, v14
    v_cvt_pk_bf16_f32 v29, v11, v15
    v_cvt_pk_bf16_f32 v30, v12, v16
    v_cvt_pk_bf16_f32 v31, v13, v17
    buffer_store_dwordx4 v[28:31], v60, s[4:7], s3 offen sc1
    s_waitcnt lgkmcnt(0)
    v_pk_add_f32 v[18:19], v[18:19], v[144:145]
    v_pk_add_f32 v[20:21], v[20:21], v[146:147]
    v_pk_add_f32 v[22:23], v[22:23], v[152:153]
    v_pk_add_f32 v[24:25], v[24:25], v[154:155]
    v_pk_add_f32 v[18:19], v[18:19], v[148:149]
    v_pk_add_f32 v[20:21], v[20:21], v[150:151]
    v_pk_add_f32 v[22:23], v[22:23], v[156:157]
    v_pk_add_f32 v[24:25], v[24:25], v[158:159]
    v_cvt_pk_bf16_f32 v32, v18, v22
    v_cvt_pk_bf16_f32 v33, v19, v23
    v_cvt_pk_bf16_f32 v34, v20, v24
    v_cvt_pk_bf16_f32 v35, v21, v25
    buffer_store_dwordx4 v[32:35], v60, s[4:7], s46 offen sc1
    s_barrier
    s_waitcnt vmcnt(2)
    s_mov_b32 exec_hi, 0xffff
    ds_write_b128 v54, v[252:255] offset:0
    ds_write_b128 v54, v[248:251] offset:3072
    ds_write_b128 v54, v[244:247] offset:6144
    ds_write_b128 v54, v[240:243] offset:9216
    ds_write_b128 v54, v[236:239] offset:12288
    ds_write_b128 v54, v[232:235] offset:15360
    ds_write_b128 v54, v[228:231] offset:18432
    ds_write_b128 v54, v[224:227] offset:21504
    ds_write_b128 v54, v[220:223] offset:24576
    ds_write_b128 v54, v[216:219] offset:27648
    ds_write_b128 v54, v[212:215] offset:30720
    ds_write_b128 v54, v[208:211] offset:33792
    ds_write_b128 v55, v[204:207] offset:0
    ds_write_b128 v55, v[200:203] offset:3072
    ds_write_b128 v55, v[196:199] offset:6144
    ds_write_b128 v55, v[192:195] offset:9216
    s_mov_b32 exec_hi, -1
    s_add_u32 m0, s34, 19200
    s_add_u32 s64, s41, 0
    buffer_load_dwordx4 v49, s[16:19], s64 offen lds
    s_add_u32 m0, s34, 23296
    s_add_u32 s64, s41, 16384
    buffer_load_dwordx4 v49, s[16:19], s64 offen lds
    s_add_u32 m0, s34, 27392
    s_add_u32 s64, s41, 32768
    buffer_load_dwordx4 v49, s[16:19], s64 offen lds
    s_add_u32 m0, s34, 31488
    s_add_u32 s64, s41, 49152
    buffer_load_dwordx4 v49, s[16:19], s64 offen lds
    s_add_u32 m0, s34, 35584
    s_cmp_eq_u32 s63, 3
    s_mov_b32 s64, 65536
    s_cmov_b32 s64, -278528
    s_add_u32 s64, s64, s41
    buffer_load_dwordx4 v49, s[16:19], s64 offen lds
    s_add_u32 m0, s34, 39680
    s_cmp_eq_u32 s63, 3
    s_mov_b32 s64, 81920
    s_cmov_b32 s64, -147456
    s_add_u32 s64, s64, s41
    buffer_load_dwordx4 v49, s[16:19], s64 offen lds
    s_add_u32 m0, s34, 43776
    s_cmp_eq_u32 s63, 3
    s_mov_b32 s64, 98304
    s_cmov_b32 s64, -16384
    s_add_u32 s64, s64, s41
    buffer_load_dwordx4 v49, s[16:19], s64 offen lds
    v_and_b32 v10, 15, v1
    v_lshrrev_b32 v11, 5, v1
    v_lshl_add_u32 v10, v10, 1, v11
    s_mul_i32 s64, s24, 4608
    v_mul_u32_u24 v19, 144, v10
    v_add_u32 v19, s64, v19
    s_lshl_b32 s64, s32, 2
    s_add_u32 s64, s64, s35
    s_lshl_b32 s64, s64, 11
    s_lshl_b32 s65, s60, 15
    s_add_u32 s64, s64, s65
    s_add_u32 s44, s64, 0x100000
    s_lshl_b32 s64, s24, 16
    s_add_u32 s45, s47, s64
    s_and_b32 s65, s3, 0x1e00
    s_add_u32 s64, s64, s65
    s_add_u32 s47, s64, 0x300000
    s_waitcnt vmcnt(7)
    s_waitcnt lgkmcnt(0)
    s_barrier
    buffer_load_dwordx4 v[96:99], v3, s[4:7], s44 offen offset:0 sc1
    buffer_load_dwordx4 v[100:103], v3, s[4:7], s44 offen offset:1024 sc1
    s_or_b32 s64, s2, s24
    s_cbranch_scc0 R_ep
B_ep:
    s_setprio 0
    v_and_b32 v10, 56, v1
    v_add_u32 v10, 163584, v10
    ds_read_b64 v[12:13], v10
    ds_read_b64 v[14:15], v10 offset:64
    v_and_b32 v10, 7, v1
    v_mul_u32_u24 v16, 576, v10
    v_and_b32 v11, 56, v1
    s_mul_i32 s64, s24, 4608
    v_add3_u32 v16, v16, v11, s64
    v_lshrrev_b32 v11, 5, v1
    v_lshl_add_u32 v10, v10, 1, v11
    v_and_b32 v17, 7, v10
    v_lshlrev_b32 v17, 4, v17
    v_lshrrev_b32 v10, 3, v10
    v_lshl_add_u32 v17, v10, 15, v17
    v_and_b32 v18, 7, v1
    v_lshlrev_b32 v18, 4, v18
    v_bfe_u32 v10, v1, 3, 1
    v_lshl_add_u32 v18, v10, 15, v18
    v_lshrrev_b32 v10, 4, v1
    v_lshl_add_u32 v18, v10, 13, v18
    s_waitcnt vmcnt(0)
    v_max3_f32 v8, |v97|, |v99|, |v101|
    v_max_f32_e64 v8, |v103|, v8
    v_cmp_le_f32 vcc, s52, v8
    s_cbranch_vccnz R_own
B_own:
    ds_write_b32 v91, v91 offset:96
    v_lshlrev_b32 v104, 16, v96
    v_and_b32 v105, 0xffff0000, v96
    v_lshlrev_b32 v106, 16, v97
    v_and_b32 v107, 0xffff0000, v97
    v_lshlrev_b32 v108, 16, v98
    v_and_b32 v109, 0xffff0000, v98
    v_lshlrev_b32 v110, 16, v99
    v_and_b32 v111, 0xffff0000, v99
    v_lshlrev_b32 v112, 16, v100
    v_and_b32 v113, 0xffff0000, v100
    v_lshlrev_b32 v114, 16, v101
    v_and_b32 v115, 0xffff0000, v101
    v_lshlrev_b32 v116, 16, v102
    v_and_b32 v117, 0xffff0000, v102
    v_lshlrev_b32 v118, 16, v103
    v_and_b32 v119, 0xffff0000, v103
    v_add_f32 v120, v104, v105
    v_mul_f32 v121, v104, v104
    v_add_f32 v120, v120, v112
    v_fmac_f32 v121, v105, v105
    v_add_f32 v120, v120, v113
    v_fmac_f32 v121, v112, v112
    v_fmac_f32 v121, v113, v113
    v_add_f32 v122, v106, v107
    v_mul_f32 v123, v106, v106
    v_add_f32 v122, v122, v114
    v_fmac_f32 v123, v107, v107
    v_add_f32 v122, v122, v115
    v_fmac_f32 v123, v114, v114
    v_fmac_f32 v123, v115, v115
    v_add_f32 v124, v108, v109
    v_mul_f32 v125, v108, v108
    v_add_f32 v124, v124, v116
    v_fmac_f32 v125, v109, v109
    v_add_f32 v124, v124, v117
    v_fmac_f32 v125, v116, v116
    v_fmac_f32 v125, v117, v117
    v_add_f32 v126, v110, v111
    v_mul_f32 v127, v110, v110
    v_add_f32 v126, v126, v118
    v_fmac_f32 v127, v111, v111
    v_add_f32 v126, v126, v119
    v_fmac_f32 v127, v118, v118
    v_fmac_f32 v127, v119, v119
    v_permlane32_swap_b32 v120, v124
    v_permlane32_swap_b32 v121, v125
    v_permlane32_swap_b32 v122, v126
    v_permlane32_swap_b32 v123, v127
    v_add_f32 v120, v120, v124
    v_add_f32 v121, v121, v125
    v_add_f32 v122, v122, v126
    v_add_f32 v123, v123, v127
    v_mov_b32 v124, v120
    v_mov_b32 v125, v121
    v_mov_b32 v126, v122
    v_mov_b32 v127, v123
    v_permlane16_swap_b32 v120, v124
    v_permlane16_swap_b32 v121, v125
    v_permlane16_swap_b32 v122, v126
    v_permlane16_swap_b32 v123, v127
    v_add_f32 v120, v120, v124
    v_add_f32 v121, v121, v125
    v_add_f32 v122, v122, v126
    v_add_f32 v123, v123, v127
    v_add_f32_dpp v120, v120, v120 row_ror:8 row_mask:0xf bank_mask:0xf
    v_add_f32_dpp v121, v121, v121 row_ror:8 row_mask:0xf bank_mask:0xf
    v_add_f32_dpp v122, v122, v122 row_ror:8 row_mask:0xf bank_mask:0xf
    v_add_f32_dpp v123, v123, v123 row_ror:8 row_mask:0xf bank_mask:0xf
    s_mov_b32 exec_lo, 0xff
    s_mov_b32 exec_hi, 0xff
    buffer_store_dwordx4 v[120:123], v17, s[4:7], s45 offen sc1
    s_mov_b64 exec, -1
    s_waitcnt lgkmcnt(0)
    v_add_f32 v104, v104, v12
    v_add_f32 v105, v105, v13
    ds_write_b64 v16, v[104:105] offset:0
    v_add_f32 v106, v106, v12
    v_add_f32 v107, v107, v13
    ds_write_b64 v16, v[106:107] offset:144
    v_add_f32 v108, v108, v12
    v_add_f32 v109, v109, v13
    ds_write_b64 v16, v[108:109] offset:288
    v_add_f32 v110, v110, v12
    v_add_f32 v111, v111, v13
    ds_write_b64 v16, v[110:111] offset:432
    v_add_f32 v112, v112, v14
    v_add_f32 v113, v113, v15
    ds_write_b64 v16, v[112:113] offset:64
    v_add_f32 v114, v114, v14
    v_add_f32 v115, v115, v15
    ds_write_b64 v16, v[114:115] offset:208
    v_add_f32 v116, v116, v14
    v_add_f32 v117, v117, v15
    ds_write_b64 v16, v[116:117] offset:352
    v_add_f32 v118, v118, v14
    v_add_f32 v119, v119, v15
    ds_write_b64 v16, v[118:119] offset:496
    ds_read_b128 v[128:131], v92 offset:64
    s_waitcnt lgkmcnt(0)
    v_min3_u32 v128, v128, v129, v130
    v_min_u32 v128, v128, v131
    v_cmp_eq_u32 vcc, 0, v128
    s_cbranch_vccnz R_fk
B_fk:
    ds_read_b128 v[128:131], v92 offset:96
    s_waitcnt lgkmcnt(0)
    v_min3_u32 v128, v128, v129, v130
    v_min_u32 v128, v128, v131
    v_cmp_eq_u32 vcc, 0, v128
    s_cbranch_vccnz R_fo
B_fo:
    s_waitcnt vmcnt(0)
    buffer_load_dwordx4 v[128:131], v18, s[4:7], s47 offen offset:0 sc1
    buffer_load_dwordx4 v[132:135], v18, s[4:7], s47 offen offset:128 sc1
    buffer_load_dwordx4 v[136:139], v18, s[4:7], s47 offen offset:256 sc1
    buffer_load_dwordx4 v[140:143], v18, s[4:7], s47 offen offset:384 sc1
    s_waitcnt vmcnt(0)
    v_xor_b32 v8, s27, v129
    v_xor_b32 v9, s27, v131
    v_min_u32 v8, v8, v9
    v_xor_b32 v9, s27, v133
    v_min_u32 v8, v8, v9
    v_xor_b32 v9, s27, v135
    v_min_u32 v8, v8, v9
    v_xor_b32 v9, s27, v137
    v_min_u32 v8, v8, v9
    v_xor_b32 v9, s27, v139
    v_min_u32 v8, v8, v9
    v_xor_b32 v9, s27, v141
    v_min_u32 v8, v8, v9
    v_xor_b32 v9, s27, v143
    v_min_u32 v8, v8, v9
    v_cmp_eq_u32 vcc, 0, v8
    s_cbranch_vccnz R_stg
B_stg:
    v_add_f32 v128, v128, v132
    v_add_f32 v136, v136, v140
    v_add_f32 v129, v129, v133
    v_add_f32 v137, v137, v141
    v_add_f32 v130, v130, v134
    v_add_f32 v138, v138, v142
    v_add_f32 v131, v131, v135
    v_add_f32 v139, v139, v143
    v_add_f32 v128, v128, v136
    v_add_f32 v129, v129, v137
    v_add_f32 v130, v130, v138
    v_add_f32 v131, v131, v139
    s_nop 0
    v_permlane32_swap_b32 v128, v130
    v_permlane32_swap_b32 v129, v131
    v_add_f32 v128, v128, v130
    v_add_f32 v129, v129, v131
    v_mov_b32 v130, v128
    v_mov_b32 v131, v129
    s_nop 0
    v_permlane16_swap_b32 v128, v130
    v_permlane16_swap_b32 v129, v131
    v_add_f32 v128, v128, v130
    v_add_f32 v129, v129, v131
    v_mul_f32 v128, 0x3b000000, v128
    v_mul_f32 v129, 0x3b000000, v129
    v_fma_f32 v129, -v128, v128, v129
    v_max_f32 v129, 0, v129
    v_add_f32 v130, 0x3727c5ac, v129
    v_fmac_f32 v129, 0x3727c5ac, v130
    v_rsq_f32 v130, v129
    s_nop 0
    v_mul_f32 v130, 0x30800000, v130
    v_mul_f32 v131, v130, v128
    ds_write_b64 v19, v[130:131] offset:128
    ds_write_b32 v91, v91 offset:48
    ds_read_b128 v[128:131], v92 offset:32
    s_waitcnt lgkmcnt(0)
    v_min3_u32 v128, v128, v129, v130
    v_min_u32 v128, v128, v131
    v_cmp_eq_u32 vcc, 0, v128
    s_cbranch_vccnz R_ff
B_ff:
    s_waitcnt vmcnt(0)
    s_add_u32 m0, s34, 47872
    s_add_u32 s64, s42, 0
    buffer_load_dwordx4 v49, s[16:19], s64 offen lds
    s_waitcnt vmcnt(4)
    s_add_u32 m0, s34, 76544
    s_add_u32 s64, s43, 0
    buffer_load_dwordx4 v49, s[16:19], s64 offen lds
    s_waitcnt vmcnt(4)
    s_add_u32 m0, s34, 105216
    s_add_u32 s64, s53, 0
    buffer_load_dwordx4 v49, s[16:19], s64 offen lds
    s_waitcnt vmcnt(4)
    s_add_u32 m0, s34, 51968
    s_add_u32 s64, s42, 16384
    buffer_load_dwordx4 v49, s[16:19], s64 offen lds
    s_waitcnt vmcnt(4)
    s_add_u32 m0, s34, 80640
    s_add_u32 s64, s43, 16384
    buffer_load_dwordx4 v49, s[16:19], s64 offen lds
    s_waitcnt vmcnt(4)
    s_add_u32 m0, s34, 109312
    s_add_u32 s64, s53, 16384
    buffer_load_dwordx4 v49, s[16:19], s64 offen lds
    s_waitcnt vmcnt(4)
    s_add_u32 m0, s34, 56064
    s_add_u32 s64, s42, 32768
    buffer_load_dwordx4 v49, s[16:19], s64 offen lds
    s_waitcnt vmcnt(4)
    s_add_u32 m0, s34, 84736
    s_add_u32 s64, s43, 32768
    buffer_load_dwordx4 v49, s[16:19], s64 offen lds
    s_waitcnt vmcnt(4)
    s_add_u32 m0, s34, 113408
    s_add_u32 s64, s53, 32768
    buffer_load_dwordx4 v49, s[16:19], s64 offen lds
    s_waitcnt vmcnt(4)
    s_add_u32 m0, s34, 60160
    s_add_u32 s64, s42, 49152
    buffer_load_dwordx4 v49, s[16:19], s64 offen lds
    s_waitcnt vmcnt(4)
    ds_write_b32 v91, v91 offset:112
    s_add_u32 m0, s34, 88832
    s_add_u32 s64, s43, 49152
    buffer_load_dwordx4 v49, s[16:19], s64 offen lds
    s_waitcnt vmcnt(4)
    s_add_u32 m0, s34, 117504
    s_add_u32 s64, s53, 49152
    buffer_load_dwordx4 v49, s[16:19], s64 offen lds
    s_waitcnt vmcnt(4)
    s_add_u32 m0, s34, 64256
    s_cmp_eq_u32 s63, 2
    s_mov_b32 s64, 65536
    s_cmov_b32 s64, -278528
    s_add_u32 s64, s64, s42
    buffer_load_dwordx4 v49, s[16:19], s64 offen lds
    s_waitcnt vmcnt(4)
    s_add_u32 m0, s34, 92928
    s_cmp_eq_u32 s63, 1
    s_mov_b32 s64, 65536
    s_cmov_b32 s64, -278528
    s_add_u32 s64, s64, s43
    buffer_load_dwordx4 v49, s[16:19], s64 offen lds
    s_waitcnt vmcnt(4)
    s_add_u32 m0, s34, 121600
    s_cmp_eq_u32 s63, 0
    s_mov_b32 s64, 65536
    s_cmov_b32 s64, -278528
    s_add_u32 s64, s64, s53
    buffer_load_dwordx4 v49, s[16:19], s64 offen lds
    s_waitcnt vmcnt(4)
    s_add_u32 m0, s34, 68352
    s_cmp_eq_u32 s63, 2
    s_mov_b32 s64, 81920
    s_cmov_b32 s64, -147456
    s_add_u32 s64, s64, s42
    buffer_load_dwordx4 v49, s[16:19], s64 offen lds
    s_waitcnt vmcnt(4)
    s_add_u32 m0, s34, 97024
    s_cmp_eq_u32 s63, 1
    s_mov_b32 s64, 81920
    s_cmov_b32 s64, -147456
    s_add_u32 s64, s64, s43
    buffer_load_dwordx4 v49, s[16:19], s64 offen lds
    s_waitcnt vmcnt(4)
    s_add_u32 m0, s34, 125696
    s_cmp_eq_u32 s63, 0
    s_mov_b32 s64, 81920
    s_cmov_b32 s64, -147456
    s_add_u32 s64, s64, s53
    buffer_load_dwordx4 v49, s[16:19], s64 offen lds
    s_waitcnt vmcnt(4)
    s_add_u32 m0, s34, 72448
    s_cmp_eq_u32 s63, 2
    s_mov_b32 s64, 98304
    s_cmov_b32 s64, -16384
    s_add_u32 s64, s64, s42
    buffer_load_dwordx4 v49, s[16:19], s64 offen lds
    s_waitcnt vmcnt(4)
    s_add_u32 m0, s34, 101120
    s_cmp_eq_u32 s63, 1
    s_mov_b32 s64, 98304
    s_cmov_b32 s64, -16384
    s_add_u32 s64, s64, s43
    buffer_load_dwordx4 v49, s[16:19], s64 offen lds
    s_waitcnt vmcnt(4)
    s_add_u32 m0, s34, 129792
    s_cmp_eq_u32 s63, 0
    s_mov_b32 s64, 98304
    s_cmov_b32 s64, -16384
    s_add_u32 s64, s64, s53
    buffer_load_dwordx4 v49, s[16:19], s64 offen lds
    s_waitcnt vmcnt(4)
    s_waitcnt vmcnt(0)
    s_waitcnt lgkmcnt(0)
    v_mov_b32 v128, -1
    ds_write_b32 v91, v128 offset:112
    s_waitcnt lgkmcnt(0)
L_endH:
    s_endpgm
R_ft:
    s_sleep 1
    ds_read_b128 v[128:131], v92 offset:80
    s_waitcnt lgkmcnt(0)
    v_min3_u32 v128, v128, v129, v130
    v_min_u32 v128, v128, v131
    v_cmp_eq_u32 vcc, 0, v128
    s_cbranch_vccnz R_ft
    s_branch B_ft
R_g1:
    s_sub_u32 s28, s28, 1
    s_cbranch_scc1 X_g1
    buffer_load_dwordx2 v[96:97], v21, s[4:7], s40 offen offset:0 sc1
    buffer_load_dwordx2 v[98:99], v21, s[4:7], s40 offen offset:128 sc1
    buffer_load_dwordx2 v[100:101], v21, s[4:7], s40 offen offset:256 sc1
    buffer_load_dwordx2 v[102:103], v21, s[4:7], s40 offen offset:384 sc1
    s_waitcnt vmcnt(0)
    v_xor_b32 v26, v36, v96
    v_xor_b32 v27, v36, v98
    v_xor_b32 v28, v37, v97
    v_xor_b32 v29, v37, v99
    v_xor_b32 v30, v36, v100
    v_xor_b32 v31, v36, v102
    v_xor_b32 v32, v37, v101
    v_xor_b32 v33, v37, v103
    ds_write_b64 v8, v[26:27] offset:33760
    ds_write_b64 v8, v[28:29] offset:38336
    ds_write_b64 v8, v[30:31] offset:35808
    ds_write_b64 v8, v[32:33] offset:40384
    v_bitop3_b32 v104, v96, v98, v34 bitop3:0x7e
    v_bitop3_b32 v105, v97, v99, v35 bitop3:0x7e
    v_bitop3_b32 v106, v100, v102, v34 bitop3:0x7e
    v_bitop3_b32 v107, v101, v103, v35 bitop3:0x7e
    v_or3_b32 v104, v104, v105, v106
    v_bitop3_b32 v104, v104, v107, s49 bitop3:0xa8
    v_cmp_ne_u32 vcc, 0, v104
    s_cbranch_vccnz R_g1
    s_branch B_g1
X_g1:
    s_mov_b32 s28, 0
    s_branch B_g1
R_rf:
    s_sub_u32 s28, s28, 1
    s_cbranch_scc1 X_rf
    buffer_load_dword v89, v62, s[4:7], 0 offen sc1
    s_waitcnt vmcnt(0)
    v_cmp_ne_u32 vcc, s51, v89
    s_cbranch_vccnz R_rf
    s_branch B_rf
X_rf:
    s_mov_b32 s28, 0
    s_branch B_rf
R_s1:
    s_sub_u32 s28, s28, 1
    s_cbranch_scc1 X_s1
    buffer_load_dwordx4 v[112:115], v2, s[4:7], s69 offen sc1
    buffer_load_dwordx4 v[116:119], v93, s[4:7], s69 offen sc1
    buffer_load_dwordx4 v[120:123], v94, s[4:7], s69 offen sc1
    buffer_load_dwordx4 v[124:127], v95, s[4:7], s69 offen sc1
    s_waitcnt vmcnt(0)
    v_min3_u32 v6, v115, v119, v123
    v_max3_u32 v7, v115, v119, v123
    v_min3_u32 v6, v127, v67, v6
    v_max3_u32 v7, v127, v67, v7
    v_cmp_ne_u32 vcc, v6, v7
    s_cbranch_vccnz R_s1
    s_branch B_s1
X_s1:
    s_mov_b32 s28, 0
    s_branch B_s1
R_ep:
    s_mov_b64 exec, 1
    buffer_store_dword v67, v3, s[4:7], 0 offen sc1
    s_mov_b64 exec, -1
    s_branch B_ep
R_own:
    s_sub_u32 s28, s28, 1
    s_cbranch_scc1 X_own
    buffer_load_dwordx4 v[96:99], v3, s[4:7], s44 offen offset:0 sc1
    buffer_load_dwordx4 v[100:103], v3, s[4:7], s44 offen offset:1024 sc1
    s_waitcnt vmcnt(0)
    v_max3_f32 v8, |v97|, |v99|, |v101|
    v_max_f32_e64 v8, |v103|, v8
    v_cmp_le_f32 vcc, s52, v8
    s_cbranch_vccnz R_own
    s_branch B_own
X_own:
    s_mov_b32 s28, 0
    s_branch B_own
R_fk:
    s_sleep 1
    ds_read_b128 v[128:131], v92 offset:64
    s_waitcnt lgkmcnt(0)
    v_min3_u32 v128, v128, v129, v130
    v_min_u32 v128, v128, v131
    v_cmp_eq_u32 vcc, 0, v128
    s_cbranch_vccnz R_fk
    s_branch B_fk
R_fo:
    s_sleep 1
    ds_read_b128 v[128:131], v92 offset:96
    s_waitcnt lgkmcnt(0)
    v_min3_u32 v128, v128, v129, v130
    v_min_u32 v128, v128, v131
    v_cmp_eq_u32 vcc, 0, v128
    s_cbranch_vccnz R_fo
    s_branch B_fo
R_stg:
    s_sub_u32 s28, s28, 1
    s_cbranch_scc1 X_stg
    buffer_load_dwordx4 v[128:131], v18, s[4:7], s47 offen offset:0 sc1
    buffer_load_dwordx4 v[132:135], v18, s[4:7], s47 offen offset:128 sc1
    buffer_load_dwordx4 v[136:139], v18, s[4:7], s47 offen offset:256 sc1
    buffer_load_dwordx4 v[140:143], v18, s[4:7], s47 offen offset:384 sc1
    s_waitcnt vmcnt(0)
    v_xor_b32 v8, s27, v129
    v_xor_b32 v9, s27, v131
    v_min_u32 v8, v8, v9
    v_xor_b32 v9, s27, v133
    v_min_u32 v8, v8, v9
    v_xor_b32 v9, s27, v135
    v_min_u32 v8, v8, v9
    v_xor_b32 v9, s27, v137
    v_min_u32 v8, v8, v9
    v_xor_b32 v9, s27, v139
    v_min_u32 v8, v8, v9
    v_xor_b32 v9, s27, v141
    v_min_u32 v8, v8, v9
    v_xor_b32 v9, s27, v143
    v_min_u32 v8, v8, v9
    v_cmp_eq_u32 vcc, 0, v8
    s_cbranch_vccnz R_stg
    s_branch B_stg
X_stg:
    s_mov_b32 s28, 0
    s_branch B_stg
R_ff:
    s_sleep 1
    ds_read_b128 v[128:131], v92 offset:32
    s_waitcnt lgkmcnt(0)
    v_min3_u32 v128, v128, v129, v130
    v_min_u32 v128, v128, v131
    v_cmp_eq_u32 vcc, 0, v128
    s_cbranch_vccnz R_ff
    s_branch B_ff
R_fa0:
    ds_read_b32 v8, v92 offset:0
    s_waitcnt lgkmcnt(0)
    v_cmp_eq_u32 vcc, 0, v8
    s_cbranch_vccnz R_fa0
    s_branch B_fa0
R_fa1:
    ds_read_b32 v8, v92 offset:0
    s_waitcnt lgkmcnt(0)
    v_cmp_eq_u32 vcc, 0, v8
    s_cbranch_vccnz R_fa1
    s_branch B_fa1
R_fc:
    ds_read_b32 v93, v92 offset:16
    s_waitcnt lgkmcnt(0)
    v_cmp_eq_u32 vcc, 0, v93
    s_cbranch_vccnz R_fc
    s_branch B_fc
R_redo:
    s_sub_u32 s28, s28, 16
    s_cbranch_scc0 R_redo2
    s_mov_b32 s28, 0
    s_branch B_redo
R_redo2:
    s_waitcnt vmcnt(0) lgkmcnt(0)
    s_nop 7
    s_nop 7
    v_mov_b64 v[128:129], 0
    v_mov_b64 v[130:131], 0
    v_mov_b64 v[132:133], 0
    v_mov_b64 v[134:135], 0
    v_mov_b64 v[136:137], 0
    v_mov_b64 v[138:139], 0
    v_mov_b64 v[140:141], 0
    v_mov_b64 v[142:143], 0
    v_mov_b64 v[144:145], 0
    v_mov_b64 v[146:147], 0
    v_mov_b64 v[148:149], 0
    v_mov_b64 v[150:151], 0
    v_mov_b64 v[152:153], 0
    v_mov_b64 v[154:155], 0
    v_mov_b64 v[156:157], 0
    v_mov_b64 v[158:159], 0
    v_mov_b64 v[160:161], 0
    v_mov_b64 v[162:163], 0
    v_mov_b64 v[164:165], 0
    v_mov_b64 v[166:167], 0
    v_mov_b64 v[168:169], 0
    v_mov_b64 v[170:171], 0
    v_mov_b64 v[172:173], 0
    v_mov_b64 v[174:175], 0
    v_mov_b64 v[176:177], 0
    v_mov_b64 v[178:179], 0
    v_mov_b64 v[180:181], 0
    v_mov_b64 v[182:183], 0
    s_cmp_eq_u32 0, 1
    s_branch L_g1start
.p2align 12
L_M:
    s_setprio 1
    v_and_b32 v6, 15, v1
    v_lshrrev_b32 v7, 4, v1
    s_mul_i32 s66, s29, 39168
    s_add_u32 s66, s66, 42752
    v_lshrrev_b32 v8, 2, v6
    v_lshlrev_b32 v8, 3, v8
    s_movk_i32 s67, 544
    v_lshl_add_u32 v86, v7, 4, s66
    v_mad_u32_u24 v84, v6, s67, v86
    s_lshl_b32 s65, s30, 8
    s_add_u32 s66, s66, s65
    s_sub_u32 m0, s66, 24576
    s_mov_b32 s64, 0xe111815
    s_mov_b32 s65, 0x14141010
    s_cmp_eq_u32 s30, 0
    s_cmov_b32 s64, 0x100500
    s_cmov_b32 s65, 0x14101410
    v_bfe_u32 v9, s64, v8, 8
    v_bfe_u32 v87, s65, v8, 8
    v_mad_u32_u24 v86, v87, s67, v86
    s_cselect_b32 s65, 0xfefeff00, 0
    v_bfe_i32 v85, s65, v8, 8
    v_and_b32 v8, 3, v6
    s_cselect_b32 s65, 3, 2
    v_min_u32 v8, s65, v8
    v_add_u32 v87, 0, v8
    v_cvt_f32_u32 v87, v87
    v_ldexp_f32 v87, v87, v85
    v_rndne_f32 v87, v87
    v_cvt_u32_f32 v87, v87
    v_add_u32 v87, v87, v9
    v_and_b32 v88, 0x3c, v87
    v_add_u32 v87, v87, v88
    v_mad_u32_u24 v80, v87, s67, v86
    v_add_u32 v87, 4, v8
    v_cvt_f32_u32 v87, v87
    v_ldexp_f32 v87, v87, v85
    v_rndne_f32 v87, v87
    v_cvt_u32_f32 v87, v87
    v_add_u32 v87, v87, v9
    v_and_b32 v88, 0x3c, v87
    v_add_u32 v87, v87, v88
    v_mad_u32_u24 v81, v87, s67, v86
    v_add_u32 v87, 8, v8
    v_cvt_f32_u32 v87, v87
    v_ldexp_f32 v87, v87, v85
    v_rndne_f32 v87, v87
    v_cvt_u32_f32 v87, v87
    v_add_u32 v87, v87, v9
    v_and_b32 v88, 0x3c, v87
    v_add_u32 v87, v87, v88
    v_mad_u32_u24 v82, v87, s67, v86
    v_add_u32 v87, 12, v8
    v_cvt_f32_u32 v87, v87
    v_ldexp_f32 v87, v87, v85
    v_rndne_f32 v87, v87
    v_cvt_u32_f32 v87, v87
    v_add_u32 v87, v87, v9
    v_and_b32 v88, 0x3c, v87
    v_add_u32 v87, v87, v88
    v_mad_u32_u24 v83, v87, s67, v86
    s_mul_i32 s64, s29, 16640
    s_lshl_b32 s65, s30, 11
    s_sub_u32 s65, s64, s65
    s_add_u32 s65, s65, 4064
    v_lshlrev_b32 v85, 5, v1
    v_sub_u32 v85, s65, v85
    s_movk_i32 s67, 4160
    v_mov_b64 v[44:45], 0
    v_mov_b64 v[46:47], 0
    v_bfe_u32 v8, v1, 1, 2
    v_and_b32 v9, 1, v1
    v_lshl_add_u32 v9, v9, 4, s64
    v_mad_u32_u24 v8, v8, s67, v9
    ds_write_b128 v8, v[44:47] offset:4096
    s_lshl_b32 s64, s24, 2
    s_add_u32 s64, s64, 163712
    v_mov_b32 v91, s64
    v_xor_b32 v92, 8, v91
    v_mov_b32 v6, 0x3fb8aa3b
    v_mov_b32 v88, 0
    s_waitcnt lgkmcnt(0)
    s_lshl_b32 s64, s29, 4
    s_lshr_b32 s61, s61, s64
    s_lshl_b32 s61, s61, 16
    s_lshr_b32 s62, s62, s64
    s_lshl_b32 s62, s62, 16
    v_mul_f32 v7, s61, v6
    v_exp_f32 v7, v7
    v_writelane_b32 v88, s62, 0
    s_waitcnt vmcnt(0)
    v_lshlrev_b32 v26, 16, v26
    v_lshlrev_b32 v27, 16, v27
    v_lshlrev_b32 v28, 16, v28
    v_lshlrev_b32 v29, 16, v29
    v_mul_f32 v26, v26, v6
    v_exp_f32 v26, v26
    s_nop 0
    v_cvt_pk_bf16_f32 v7, v7, v26
    v_and_b32 v26, 0xffff0000, v7
    v_lshlrev_b32 v7, 16, v7
    v_mul_f32 v26, v26, v7
    v_mul_f32 v27, v27, v7
    v_mul_f32 v26, 0xbfb8aa3b, v26
    v_mul_f32 v27, 0.15915494, v27
    v_mul_f32 v7, 0x44000000, v7
    v_mul_f32 v166, v28, v7
    v_mul_f32_e64 v167, v29, -v7
    v_exp_f32 v170, v26
    v_fract_f32 v171, v27
    v_cos_f32 v134, v171
    v_sin_f32 v135, v171
    v_mul_f32 v172, 0x41800000, v26
    v_mul_f32 v173, 0x41800000, v27
    v_exp_f32 v172, v172
    v_fract_f32 v173, v173
    v_cos_f32 v164, v173
    v_sin_f32 v165, v173
    v_mul_f32 v174, 0x43800000, v26
    v_mul_f32 v175, 0x43800000, v27
    v_exp_f32 v174, v174
    v_fract_f32 v175, v175
    v_cos_f32 v132, v175
    v_sin_f32 v133, v175
    .p2align 3
    v_pk_mul_f32 v[134:135], v[134:135], v[170:171] op_sel_hi:[1,0]
    v_pk_mul_f32 v[164:165], v[164:165], v[172:173] op_sel_hi:[1,0]
    v_pk_mul_f32 v[132:133], v[132:133], v[174:175] op_sel_hi:[1,0]
    v_mov_b32 v180, 0x3f80
    v_cvt_pk_bf16_f32 v181, v134, v135
    ds_write_addtid_b32 v180 offset:33280
    ds_write_addtid_b32 v181 offset:33824
    v_cvt_pk_bf16_f32 v182, v166, v167
    v_pk_mul_f32 v[170:171], v[166:167], v[164:165] op_sel_hi:[1,0]
    v_pk_fma_f32 v[168:169], v[166:167], v[164:165], v[170:171] op_sel:[1,1,0] op_sel_hi:[0,1,1] neg_hi:[1,0,0]
    v_cvt_pk_bf16_f32 v183, v168, v169
    ds_write_addtid_b32 v182 offset:24576
    ds_write_addtid_b32 v183 offset:25120
    v_pk_mul_f32 v[170:171], v[168:169], v[164:165] op_sel_hi:[1,0]
    v_pk_fma_f32 v[166:167], v[168:169], v[164:165], v[170:171] op_sel:[1,1,0] op_sel_hi:[0,1,1] neg_hi:[1,0,0]
    v_cvt_pk_bf16_f32 v184, v166, v167
    v_pk_mul_f32 v[172:173], v[134:135], v[134:135] op_sel_hi:[1,0]
    v_pk_fma_f32 v[136:137], v[134:135], v[134:135], v[172:173] op_sel:[1,1,0] op_sel_hi:[0,1,1] neg_lo:[1,0,0]
    v_cvt_pk_bf16_f32 v185, v136, v137
    ds_write_addtid_b32 v184 offset:25664
    ds_write_addtid_b32 v185 offset:34368
    v_pk_mul_f32 v[170:171], v[166:167], v[164:165] op_sel_hi:[1,0]
    v_pk_fma_f32 v[168:169], v[166:167], v[164:165], v[170:171] op_sel:[1,1,0] op_sel_hi:[0,1,1] neg_hi:[1,0,0]
    v_cvt_pk_bf16_f32 v186, v168, v169
    v_pk_mul_f32 v[172:173], v[136:137], v[134:135] op_sel_hi:[1,0]
    v_pk_fma_f32 v[138:139], v[136:137], v[134:135], v[172:173] op_sel:[1,1,0] op_sel_hi:[0,1,1] neg_lo:[1,0,0]
    v_cvt_pk_bf16_f32 v187, v138, v139
    ds_write_addtid_b32 v186 offset:26208
    ds_write_addtid_b32 v187 offset:34912
    v_pk_mul_f32 v[170:171], v[168:169], v[164:165] op_sel_hi:[1,0]
    v_pk_fma_f32 v[166:167], v[168:169], v[164:165], v[170:171] op_sel:[1,1,0] op_sel_hi:[0,1,1] neg_hi:[1,0,0]
    v_cvt_pk_bf16_f32 v180, v166, v167
    v_pk_mul_f32 v[172:173], v[138:139], v[134:135] op_sel_hi:[1,0]
    v_pk_fma_f32 v[140:141], v[138:139], v[134:135], v[172:173] op_sel:[1,1,0] op_sel_hi:[0,1,1] neg_lo:[1,0,0]
    v_cvt_pk_bf16_f32 v181, v140, v141
    ds_write_addtid_b32 v180 offset:26752
    ds_write_addtid_b32 v181 offset:37632
    v_pk_mul_f32 v[170:171], v[166:167], v[164:165] op_sel_hi:[1,0]
    v_pk_fma_f32 v[168:169], v[166:167], v[164:165], v[170:171] op_sel:[1,1,0] op_sel_hi:[0,1,1] neg_hi:[1,0,0]
    v_cvt_pk_bf16_f32 v182, v168, v169
    v_pk_mul_f32 v[172:173], v[140:141], v[134:135] op_sel_hi:[1,0]
    v_pk_fma_f32 v[142:143], v[140:141], v[134:135], v[172:173] op_sel:[1,1,0] op_sel_hi:[0,1,1] neg_lo:[1,0,0]
    v_cvt_pk_bf16_f32 v183, v142, v143
    ds_write_addtid_b32 v182 offset:27296
    ds_write_addtid_b32 v183 offset:38176
    v_pk_mul_f32 v[170:171], v[168:169], v[164:165] op_sel_hi:[1,0]
    v_pk_fma_f32 v[166:167], v[168:169], v[164:165], v[170:171] op_sel:[1,1,0] op_sel_hi:[0,1,1] neg_hi:[1,0,0]
    v_cvt_pk_bf16_f32 v184, v166, v167
    v_pk_mul_f32 v[172:173], v[142:143], v[134:135] op_sel_hi:[1,0]
    v_pk_fma_f32 v[144:145], v[142:143], v[134:135], v[172:173] op_sel:[1,1,0] op_sel_hi:[0,1,1] neg_lo:[1,0,0]
    v_cvt_pk_bf16_f32 v185, v144, v145
    ds_write_addtid_b32 v184 offset:27840
    ds_write_addtid_b32 v185 offset:38720
    v_pk_mul_f32 v[170:171], v[166:167], v[164:165] op_sel_hi:[1,0]
    v_pk_fma_f32 v[168:169], v[166:167], v[164:165], v[170:171] op_sel:[1,1,0] op_sel_hi:[0,1,1] neg_hi:[1,0,0]
    v_cvt_pk_bf16_f32 v186, v168, v169
    v_pk_mul_f32 v[172:173], v[144:145], v[134:135] op_sel_hi:[1,0]
    v_pk_fma_f32 v[146:147], v[144:145], v[134:135], v[172:173] op_sel:[1,1,0] op_sel_hi:[0,1,1] neg_lo:[1,0,0]
    v_cvt_pk_bf16_f32 v187, v146, v147
    ds_write_addtid_b32 v186 offset:28384
    ds_write_addtid_b32 v187 offset:39264
    v_pk_mul_f32 v[170:171], v[168:169], v[164:165] op_sel_hi:[1,0]
    v_pk_fma_f32 v[166:167], v[168:169], v[164:165], v[170:171] op_sel:[1,1,0] op_sel_hi:[0,1,1] neg_hi:[1,0,0]
    v_cvt_pk_bf16_f32 v180, v166, v167
    v_pk_mul_f32 v[172:173], v[146:147], v[134:135] op_sel_hi:[1,0]
    v_pk_fma_f32 v[148:149], v[146:147], v[134:135], v[172:173] op_sel:[1,1,0] op_sel_hi:[0,1,1] neg_lo:[1,0,0]
    v_cvt_pk_bf16_f32 v181, v148, v149
    ds_write_addtid_b32 v180 offset:28928
    ds_write_addtid_b32 v181 offset:41984
    v_pk_mul_f32 v[170:171], v[166:167], v[164:165] op_sel_hi:[1,0]
    v_pk_fma_f32 v[168:169], v[166:167], v[164:165], v[170:171] op_sel:[1,1,0] op_sel_hi:[0,1,1] neg_hi:[1,0,0]
    v_cvt_pk_bf16_f32 v182, v168, v169
    v_pk_mul_f32 v[172:173], v[148:149], v[134:135] op_sel_hi:[1,0]
    v_pk_fma_f32 v[150:151], v[148:149], v[134:135], v[172:173] op_sel:[1,1,0] op_sel_hi:[0,1,1] neg_lo:[1,0,0]
    v_cvt_pk_bf16_f32 v183, v150, v151
    ds_write_addtid_b32 v182 offset:29472
    ds_write_addtid_b32 v183 offset:42528
    v_pk_mul_f32 v[170:171], v[168:169], v[164:165] op_sel_hi:[1,0]
    v_pk_fma_f32 v[166:167], v[168:169], v[164:165], v[170:171] op_sel:[1,1,0] op_sel_hi:[0,1,1] neg_hi:[1,0,0]
    v_cvt_pk_bf16_f32 v184, v166, v167
    v_pk_mul_f32 v[172:173], v[150:151], v[134:135] op_sel_hi:[1,0]
    v_pk_fma_f32 v[152:153], v[150:151], v[134:135], v[172:173] op_sel:[1,1,0] op_sel_hi:[0,1,1] neg_lo:[1,0,0]
    v_cvt_pk_bf16_f32 v185, v152, v153
    ds_write_addtid_b32 v184 offset:30016
    ds_write_addtid_b32 v185 offset:43072
    v_pk_mul_f32 v[170:171], v[166:167], v[164:165] op_sel_hi:[1,0]
    v_pk_fma_f32 v[168:169], v[166:167], v[164:165], v[170:171] op_sel:[1,1,0] op_sel_hi:[0,1,1] neg_hi:[1,0,0]
    v_cvt_pk_bf16_f32 v186, v168, v169
    v_pk_mul_f32 v[172:173], v[152:153], v[134:135] op_sel_hi:[1,0]
    v_pk_fma_f32 v[154:155], v[152:153], v[134:135], v[172:173] op_sel:[1,1,0] op_sel_hi:[0,1,1] neg_lo:[1,0,0]
    v_cvt_pk_bf16_f32 v187, v154, v155
    ds_write_addtid_b32 v186 offset:30560
    ds_write_addtid_b32 v187 offset:43616
    v_pk_mul_f32 v[170:171], v[168:169], v[164:165] op_sel_hi:[1,0]
    v_pk_fma_f32 v[166:167], v[168:169], v[164:165], v[170:171] op_sel:[1,1,0] op_sel_hi:[0,1,1] neg_hi:[1,0,0]
    v_cvt_pk_bf16_f32 v180, v166, v167
    v_pk_mul_f32 v[172:173], v[154:155], v[134:135] op_sel_hi:[1,0]
    v_pk_fma_f32 v[156:157], v[154:155], v[134:135], v[172:173] op_sel:[1,1,0] op_sel_hi:[0,1,1] neg_lo:[1,0,0]
    v_cvt_pk_bf16_f32 v181, v156, v157
    ds_write_addtid_b32 v180 offset:31104
    ds_write_addtid_b32 v181 offset:46336
    v_pk_mul_f32 v[170:171], v[166:167], v[164:165] op_sel_hi:[1,0]
    v_pk_fma_f32 v[168:169], v[166:167], v[164:165], v[170:171] op_sel:[1,1,0] op_sel_hi:[0,1,1] neg_hi:[1,0,0]
    v_cvt_pk_bf16_f32 v182, v168, v169
    v_pk_mul_f32 v[172:173], v[156:157], v[134:135] op_sel_hi:[1,0]
    v_pk_fma_f32 v[158:159], v[156:157], v[134:135], v[172:173] op_sel:[1,1,0] op_sel_hi:[0,1,1] neg_lo:[1,0,0]
    v_cvt_pk_bf16_f32 v183, v158, v159
    ds_write_addtid_b32 v182 offset:31648
    ds_write_addtid_b32 v183 offset:46880
    v_pk_mul_f32 v[170:171], v[168:169], v[164:165] op_sel_hi:[1,0]
    v_pk_fma_f32 v[166:167], v[168:169], v[164:165], v[170:171] op_sel:[1,1,0] op_sel_hi:[0,1,1] neg_hi:[1,0,0]
    v_cvt_pk_bf16_f32 v184, v166, v167
    v_pk_mul_f32 v[172:173], v[158:159], v[134:135] op_sel_hi:[1,0]
    v_pk_fma_f32 v[160:161], v[158:159], v[134:135], v[172:173] op_sel:[1,1,0] op_sel_hi:[0,1,1] neg_lo:[1,0,0]
    v_cvt_pk_bf16_f32 v185, v160, v161
    ds_write_addtid_b32 v184 offset:32192
    ds_write_addtid_b32 v185 offset:47424
    v_pk_mul_f32 v[170:171], v[166:167], v[164:165] op_sel_hi:[1,0]
    v_pk_fma_f32 v[168:169], v[166:167], v[164:165], v[170:171] op_sel:[1,1,0] op_sel_hi:[0,1,1] neg_hi:[1,0,0]
    v_cvt_pk_bf16_f32 v186, v168, v169
    v_pk_mul_f32 v[172:173], v[160:161], v[134:135] op_sel_hi:[1,0]
    v_pk_fma_f32 v[162:163], v[160:161], v[134:135], v[172:173] op_sel:[1,1,0] op_sel_hi:[0,1,1] neg_lo:[1,0,0]
    v_cvt_pk_bf16_f32 v187, v162, v163
    ds_write_addtid_b32 v186 offset:32736
    ds_write_addtid_b32 v187 offset:47968
    v_cvt_pk_bf16_f32 v180, v132, v133
    v_pk_mul_f32 v[166:167], v[132:133], v[136:137] op_sel_hi:[1,0]
    v_pk_fma_f32 v[168:169], v[132:133], v[136:137], v[166:167] op_sel:[1,1,0] op_sel_hi:[0,1,1] neg_lo:[1,0,0]
    v_cvt_pk_bf16_f32 v181, v168, v169
    ds_write_addtid_b32 v180 offset:40352
    ds_write_addtid_b32 v181 offset:40896
    v_pk_mul_f32 v[172:173], v[132:133], v[140:141] op_sel_hi:[1,0]
    v_pk_fma_f32 v[178:179], v[132:133], v[140:141], v[172:173] op_sel:[1,1,0] op_sel_hi:[0,1,1] neg_lo:[1,0,0]
    v_cvt_pk_bf16_f32 v182, v178, v179
    v_pk_mul_f32 v[166:167], v[132:133], v[144:145] op_sel_hi:[1,0]
    v_pk_fma_f32 v[168:169], v[132:133], v[144:145], v[166:167] op_sel:[1,1,0] op_sel_hi:[0,1,1] neg_lo:[1,0,0]
    v_cvt_pk_bf16_f32 v183, v168, v169
    ds_write_addtid_b32 v182 offset:41440
    ds_write_addtid_b32 v183 offset:44160
    v_pk_mul_f32 v[172:173], v[132:133], v[148:149] op_sel_hi:[1,0]
    v_pk_fma_f32 v[178:179], v[132:133], v[148:149], v[172:173] op_sel:[1,1,0] op_sel_hi:[0,1,1] neg_lo:[1,0,0]
    v_cvt_pk_bf16_f32 v184, v178, v179
    v_pk_mul_f32 v[166:167], v[132:133], v[152:153] op_sel_hi:[1,0]
    v_pk_fma_f32 v[168:169], v[132:133], v[152:153], v[166:167] op_sel:[1,1,0] op_sel_hi:[0,1,1] neg_lo:[1,0,0]
    v_cvt_pk_bf16_f32 v185, v168, v169
    ds_write_addtid_b32 v184 offset:44704
    ds_write_addtid_b32 v185 offset:45248
    v_pk_mul_f32 v[172:173], v[132:133], v[156:157] op_sel_hi:[1,0]
    v_pk_fma_f32 v[178:179], v[132:133], v[156:157], v[172:173] op_sel:[1,1,0] op_sel_hi:[0,1,1] neg_lo:[1,0,0]
    v_cvt_pk_bf16_f32 v186, v178, v179
    v_pk_mul_f32 v[166:167], v[132:133], v[160:161] op_sel_hi:[1,0]
    v_pk_fma_f32 v[168:169], v[132:133], v[160:161], v[166:167] op_sel:[1,1,0] op_sel_hi:[0,1,1] neg_lo:[1,0,0]
    v_cvt_pk_bf16_f32 v187, v168, v169
    ds_write_addtid_b32 v186 offset:45792
    ds_write_addtid_b32 v187 offset:48512
    v_pk_mul_f32 v[172:173], v[132:133], v[164:165] op_sel_hi:[1,0]
    v_pk_fma_f32 v[178:179], v[132:133], v[164:165], v[172:173] op_sel:[1,1,0] op_sel_hi:[0,1,1] neg_lo:[1,0,0]
    v_cvt_pk_bf16_f32 v180, v178, v179
    v_pk_mul_f32 v[170:171], v[132:133], v[132:133] op_sel_hi:[1,0]
    v_pk_fma_f32 v[174:175], v[132:133], v[132:133], v[170:171] op_sel:[1,1,0] op_sel_hi:[0,1,1] neg_lo:[1,0,0]
    v_cvt_pk_bf16_f32 v181, v174, v175
    ds_write_addtid_b32 v180 offset:49056
    ds_write_addtid_b32 v181 offset:50688
    v_pk_mul_f32 v[166:167], v[174:175], v[140:141] op_sel_hi:[1,0]
    v_pk_fma_f32 v[168:169], v[174:175], v[140:141], v[166:167] op_sel:[1,1,0] op_sel_hi:[0,1,1] neg_lo:[1,0,0]
    v_cvt_pk_bf16_f32 v182, v168, v169
    v_pk_mul_f32 v[172:173], v[174:175], v[148:149] op_sel_hi:[1,0]
    v_pk_fma_f32 v[178:179], v[174:175], v[148:149], v[172:173] op_sel:[1,1,0] op_sel_hi:[0,1,1] neg_lo:[1,0,0]
    v_cvt_pk_bf16_f32 v183, v178, v179
    ds_write_addtid_b32 v182 offset:51232
    ds_write_addtid_b32 v183 offset:51776
    v_pk_mul_f32 v[166:167], v[174:175], v[156:157] op_sel_hi:[1,0]
    v_pk_fma_f32 v[168:169], v[174:175], v[156:157], v[166:167] op_sel:[1,1,0] op_sel_hi:[0,1,1] neg_lo:[1,0,0]
    v_cvt_pk_bf16_f32 v184, v168, v169
    v_pk_mul_f32 v[172:173], v[174:175], v[164:165] op_sel_hi:[1,0]
    v_pk_fma_f32 v[178:179], v[174:175], v[164:165], v[172:173] op_sel:[1,1,0] op_sel_hi:[0,1,1] neg_lo:[1,0,0]
    v_cvt_pk_bf16_f32 v185, v178, v179
    ds_write_addtid_b32 v184 offset:52320
    ds_write_addtid_b32 v185 offset:55040
    v_pk_mul_f32 v[170:171], v[174:175], v[132:133] op_sel_hi:[1,0]
    v_pk_fma_f32 v[176:177], v[174:175], v[132:133], v[170:171] op_sel:[1,1,0] op_sel_hi:[0,1,1] neg_lo:[1,0,0]
    v_cvt_pk_bf16_f32 v186, v176, v177
    v_pk_mul_f32 v[166:167], v[176:177], v[140:141] op_sel_hi:[1,0]
    v_pk_fma_f32 v[168:169], v[176:177], v[140:141], v[166:167] op_sel:[1,1,0] op_sel_hi:[0,1,1] neg_lo:[1,0,0]
    v_cvt_pk_bf16_f32 v187, v168, v169
    ds_write_addtid_b32 v186 offset:35456
    ds_write_addtid_b32 v187 offset:36000
    v_pk_mul_f32 v[172:173], v[176:177], v[148:149] op_sel_hi:[1,0]
    v_pk_fma_f32 v[178:179], v[176:177], v[148:149], v[172:173] op_sel:[1,1,0] op_sel_hi:[0,1,1] neg_lo:[1,0,0]
    v_cvt_pk_bf16_f32 v180, v178, v179
    v_pk_mul_f32 v[166:167], v[176:177], v[156:157] op_sel_hi:[1,0]
    v_pk_fma_f32 v[168:169], v[176:177], v[156:157], v[166:167] op_sel:[1,1,0] op_sel_hi:[0,1,1] neg_lo:[1,0,0]
    v_cvt_pk_bf16_f32 v181, v168, v169
    ds_write_addtid_b32 v180 offset:36544
    ds_write_addtid_b32 v181 offset:37088
    v_pk_mul_f32 v[172:173], v[176:177], v[164:165] op_sel_hi:[1,0]
    v_pk_fma_f32 v[178:179], v[176:177], v[164:165], v[172:173] op_sel:[1,1,0] op_sel_hi:[0,1,1] neg_lo:[1,0,0]
    v_cvt_pk_bf16_f32 v182, v178, v179
    v_pk_mul_f32 v[170:171], v[176:177], v[132:133] op_sel_hi:[1,0]
    v_pk_fma_f32 v[174:175], v[176:177], v[132:133], v[170:171] op_sel:[1,1,0] op_sel_hi:[0,1,1] neg_lo:[1,0,0]
    v_cvt_pk_bf16_f32 v183, v174, v175
    ds_write_addtid_b32 v182 offset:39808
    ds_write_addtid_b32 v183 offset:55584
    v_pk_mul_f32 v[166:167], v[174:175], v[148:149] op_sel_hi:[1,0]
    v_pk_fma_f32 v[168:169], v[174:175], v[148:149], v[166:167] op_sel:[1,1,0] op_sel_hi:[0,1,1] neg_lo:[1,0,0]
    v_cvt_pk_bf16_f32 v184, v168, v169
    v_pk_mul_f32 v[172:173], v[174:175], v[164:165] op_sel_hi:[1,0]
    v_pk_fma_f32 v[178:179], v[174:175], v[164:165], v[172:173] op_sel:[1,1,0] op_sel_hi:[0,1,1] neg_lo:[1,0,0]
    v_cvt_pk_bf16_f32 v185, v178, v179
    ds_write_addtid_b32 v184 offset:56128
    ds_write_addtid_b32 v185 offset:56672
    v_pk_mul_f32 v[170:171], v[174:175], v[132:133] op_sel_hi:[1,0]
    v_pk_fma_f32 v[176:177], v[174:175], v[132:133], v[170:171] op_sel:[1,1,0] op_sel_hi:[0,1,1] neg_lo:[1,0,0]
    v_cvt_pk_bf16_f32 v186, v176, v177
    v_pk_mul_f32 v[166:167], v[176:177], v[148:149] op_sel_hi:[1,0]
    v_pk_fma_f32 v[168:169], v[176:177], v[148:149], v[166:167] op_sel:[1,1,0] op_sel_hi:[0,1,1] neg_lo:[1,0,0]
    v_cvt_pk_bf16_f32 v187, v168, v169
    ds_write_addtid_b32 v186 offset:59392
    ds_write_addtid_b32 v187 offset:59936
    v_pk_mul_f32 v[172:173], v[176:177], v[164:165] op_sel_hi:[1,0]
    v_pk_fma_f32 v[178:179], v[176:177], v[164:165], v[172:173] op_sel:[1,1,0] op_sel_hi:[0,1,1] neg_lo:[1,0,0]
    v_cvt_pk_bf16_f32 v180, v178, v179
    v_pk_mul_f32 v[170:171], v[176:177], v[132:133] op_sel_hi:[1,0]
    v_pk_fma_f32 v[174:175], v[176:177], v[132:133], v[170:171] op_sel:[1,1,0] op_sel_hi:[0,1,1] neg_lo:[1,0,0]
    v_cvt_pk_bf16_f32 v181, v174, v175
    ds_write_addtid_b32 v180 offset:60480
    ds_write_addtid_b32 v181 offset:53408
    v_pk_mul_f32 v[166:167], v[174:175], v[148:149] op_sel_hi:[1,0]
    v_pk_fma_f32 v[168:169], v[174:175], v[148:149], v[166:167] op_sel:[1,1,0] op_sel_hi:[0,1,1] neg_lo:[1,0,0]
    v_cvt_pk_bf16_f32 v182, v168, v169
    v_pk_mul_f32 v[172:173], v[174:175], v[164:165] op_sel_hi:[1,0]
    v_pk_fma_f32 v[178:179], v[174:175], v[164:165], v[172:173] op_sel:[1,1,0] op_sel_hi:[0,1,1] neg_lo:[1,0,0]
    v_cvt_pk_bf16_f32 v183, v178, v179
    ds_write_addtid_b32 v182 offset:53952
    ds_write_addtid_b32 v183 offset:54496
    v_pk_mul_f32 v[170:171], v[174:175], v[132:133] op_sel_hi:[1,0]
    v_pk_fma_f32 v[176:177], v[174:175], v[132:133], v[170:171] op_sel:[1,1,0] op_sel_hi:[0,1,1] neg_lo:[1,0,0]
    v_cvt_pk_bf16_f32 v184, v176, v177
    v_pk_mul_f32 v[166:167], v[176:177], v[148:149] op_sel_hi:[1,0]
    v_pk_fma_f32 v[168:169], v[176:177], v[148:149], v[166:167] op_sel:[1,1,0] op_sel_hi:[0,1,1] neg_lo:[1,0,0]
    v_cvt_pk_bf16_f32 v185, v168, v169
    ds_write_addtid_b32 v184 offset:49600
    ds_write_addtid_b32 v185 offset:50144
    v_pk_mul_f32 v[172:173], v[176:177], v[164:165] op_sel_hi:[1,0]
    v_pk_fma_f32 v[178:179], v[176:177], v[164:165], v[172:173] op_sel:[1,1,0] op_sel_hi:[0,1,1] neg_lo:[1,0,0]
    v_cvt_pk_bf16_f32 v186, v178, v179
    ds_write_addtid_b32 v186 offset:52864
    ds_write_b32 v91, v91 offset:0
    s_cmp_lg_u32 s30, 0
    s_cbranch_scc1 L_kz1
    ds_read_b128 v[128:131], v84 offset:0
    ds_read_b128 v[132:135], v80 offset:0
    ds_read_b128 v[136:139], v81 offset:0
    ds_read_b128 v[140:143], v82 offset:0
    ds_read_b128 v[144:147], v83 offset:0
    ds_read_b128 v[148:151], v84 offset:64
    ds_read_b128 v[152:155], v80 offset:64
    ds_read_b128 v[156:159], v81 offset:64
    ds_read_b128 v[160:163], v82 offset:64
    ds_read_b128 v[164:167], v83 offset:64
    ds_read_b128 v[168:171], v84 offset:128
    s_waitcnt lgkmcnt(6)
    v_mfma_f32_16x16x32_bf16 v[224:227], v[132:135], v[128:131], 0
    ds_read_b128 v[172:175], v80 offset:128
    v_mfma_f32_16x16x32_bf16 v[228:231], v[136:139], v[128:131], 0
    ds_read_b128 v[176:179], v81 offset:128
    v_mfma_f32_16x16x32_bf16 v[232:235], v[140:143], v[128:131], 0
    ds_read_b128 v[180:183], v82 offset:128
    v_mfma_f32_16x16x32_bf16 v[236:239], v[144:147], v[128:131], 0
    ds_read_b128 v[184:187], v83 offset:128
    ds_read_b128 v[188:191], v84 offset:192
    ds_read_b32 v8, v92 offset:0
    s_waitcnt lgkmcnt(7)
    v_mfma_f32_16x16x32_bf16 v[224:227], v[152:155], v[148:151], v[224:227]
    ds_read_b128 v[192:195], v80 offset:192
    v_mfma_f32_16x16x32_bf16 v[228:231], v[156:159], v[148:151], v[228:231]
    ds_read_b128 v[196:199], v81 offset:192
    v_mfma_f32_16x16x32_bf16 v[232:235], v[160:163], v[148:151], v[232:235]
    ds_read_b128 v[200:203], v82 offset:192
    v_mfma_f32_16x16x32_bf16 v[236:239], v[164:167], v[148:151], v[236:239]
    ds_read_b128 v[204:207], v83 offset:192
    s_waitcnt lgkmcnt(4)
    v_cmp_eq_u32 vcc, 0, v8
    s_cbranch_vccnz R_fa0
B_fa0:
    ds_read_b128 v[128:131], v84 offset:256
    ds_write_b32 v91, v91 offset:80
    v_mfma_f32_16x16x32_bf16 v[224:227], v[172:175], v[168:171], v[224:227]
    ds_read_b128 v[132:135], v80 offset:256
    v_mfma_f32_16x16x32_bf16 v[228:231], v[176:179], v[168:171], v[228:231]
    ds_read_b128 v[136:139], v81 offset:256
    v_mfma_f32_16x16x32_bf16 v[232:235], v[180:183], v[168:171], v[232:235]
    ds_read_b128 v[140:143], v82 offset:256
    v_mfma_f32_16x16x32_bf16 v[236:239], v[184:187], v[168:171], v[236:239]
    ds_read_b128 v[144:147], v83 offset:256
    ds_read_b128 v[148:151], v84 offset:320
    s_waitcnt lgkmcnt(7)
    v_mfma_f32_16x16x32_bf16 v[224:227], v[192:195], v[188:191], v[224:227]
    ds_read_b128 v[152:155], v80 offset:320
    v_mfma_f32_16x16x32_bf16 v[228:231], v[196:199], v[188:191], v[228:231]
    ds_read_b128 v[156:159], v81 offset:320
    v_mfma_f32_16x16x32_bf16 v[232:235], v[200:203], v[188:191], v[232:235]
    ds_read_b128 v[160:163], v82 offset:320
    v_mfma_f32_16x16x32_bf16 v[236:239], v[204:207], v[188:191], v[236:239]
    ds_read_b128 v[164:167], v83 offset:320
    ds_read_b128 v[168:171], v84 offset:384
    s_waitcnt lgkmcnt(6)
    v_mfma_f32_16x16x32_bf16 v[224:227], v[132:135], v[128:131], v[224:227]
    ds_read_b128 v[172:175], v80 offset:384
    v_mfma_f32_16x16x32_bf16 v[228:231], v[136:139], v[128:131], v[228:231]
    ds_read_b128 v[176:179], v81 offset:384
    v_mfma_f32_16x16x32_bf16 v[232:235], v[140:143], v[128:131], v[232:235]
    ds_read_b128 v[180:183], v82 offset:384
    v_mfma_f32_16x16x32_bf16 v[236:239], v[144:147], v[128:131], v[236:239]
    ds_read_b128 v[184:187], v83 offset:384
    ds_read_b128 v[188:191], v84 offset:448
    s_waitcnt lgkmcnt(6)
    v_mfma_f32_16x16x32_bf16 v[224:227], v[152:155], v[148:151], v[224:227]
    ds_read_b128 v[192:195], v80 offset:448
    v_mfma_f32_16x16x32_bf16 v[228:231], v[156:159], v[148:151], v[228:231]
    ds_read_b128 v[196:199], v81 offset:448
    v_mfma_f32_16x16x32_bf16 v[232:235], v[160:163], v[148:151], v[232:235]
    ds_read_b128 v[200:203], v82 offset:448
    v_mfma_f32_16x16x32_bf16 v[236:239], v[164:167], v[148:151], v[236:239]
    ds_read_b128 v[204:207], v83 offset:448
    s_waitcnt lgkmcnt(5)
    v_mfma_f32_16x16x32_bf16 v[224:227], v[172:175], v[168:171], v[224:227]
    v_mfma_f32_16x16x32_bf16 v[228:231], v[176:179], v[168:171], v[228:231]
    v_mfma_f32_16x16x32_bf16 v[232:235], v[180:183], v[168:171], v[232:235]
    v_mfma_f32_16x16x32_bf16 v[236:239], v[184:187], v[168:171], v[236:239]
    s_waitcnt lgkmcnt(0)
    v_mfma_f32_16x16x32_bf16 v[224:227], v[192:195], v[188:191], v[224:227]
    v_mfma_f32_16x16x32_bf16 v[228:231], v[196:199], v[188:191], v[228:231]
    v_mfma_f32_16x16x32_bf16 v[232:235], v[200:203], v[188:191], v[232:235]
    v_mfma_f32_16x16x32_bf16 v[236:239], v[204:207], v[188:191], v[236:239]
    s_nop 4
    v_fmac_f32 v224, 0x43800000, v88
    s_nop 1
    v_mov_b32 v240, v239
    v_mov_b32 v241, v239
    v_mov_b32 v242, v239
    v_mov_b32_dpp v240, v224 wave_shl:1 row_mask:0xf bank_mask:0xf
    v_mov_b32_dpp v241, v225 wave_shl:1 row_mask:0xf bank_mask:0xf
    v_mov_b32_dpp v242, v226 wave_shl:1 row_mask:0xf bank_mask:0xf
    v_cvt_pk_bf16_f32 v128, v239, v238
    v_cvt_pk_bf16_f32 v129, v237, v236
    v_cvt_pk_bf16_f32 v130, v235, v234
    v_cvt_pk_bf16_f32 v131, v233, v232
    ds_write_b128 v85, v[128:131] offset:0
    v_cvt_pk_bf16_f32 v132, v231, v230
    v_cvt_pk_bf16_f32 v133, v229, v228
    v_cvt_pk_bf16_f32 v134, v227, v226
    v_cvt_pk_bf16_f32 v135, v225, v224
    ds_write_b128 v85, v[132:135] offset:16
    v_cvt_pk_bf16_f32 v136, v240, v239
    v_cvt_pk_bf16_f32 v137, v238, v237
    v_cvt_pk_bf16_f32 v138, v236, v235
    v_cvt_pk_bf16_f32 v139, v234, v233
    ds_write_b128 v85, v[136:139] offset:4160
    v_cvt_pk_bf16_f32 v140, v232, v231
    v_cvt_pk_bf16_f32 v141, v230, v229
    v_cvt_pk_bf16_f32 v142, v228, v227
    v_cvt_pk_bf16_f32 v143, v226, v225
    ds_write_b128 v85, v[140:143] offset:4176
    v_cvt_pk_bf16_f32 v144, v241, v240
    v_cvt_pk_bf16_f32 v145, v239, v238
    v_cvt_pk_bf16_f32 v146, v237, v236
    v_cvt_pk_bf16_f32 v147, v235, v234
    ds_write_b128 v85, v[144:147] offset:8320
    v_cvt_pk_bf16_f32 v148, v233, v232
    v_cvt_pk_bf16_f32 v149, v231, v230
    v_cvt_pk_bf16_f32 v150, v229, v228
    v_cvt_pk_bf16_f32 v151, v227, v226
    ds_write_b128 v85, v[148:151] offset:8336
    v_cvt_pk_bf16_f32 v152, v242, v241
    v_cvt_pk_bf16_f32 v153, v240, v239
    v_cvt_pk_bf16_f32 v154, v238, v237
    v_cvt_pk_bf16_f32 v155, v236, v235
    ds_write_b128 v85, v[152:155] offset:12480
    v_cvt_pk_bf16_f32 v156, v234, v233
    v_cvt_pk_bf16_f32 v157, v232, v231
    v_cvt_pk_bf16_f32 v158, v230, v229
    v_cvt_pk_bf16_f32 v159, v228, v227
    ds_write_b128 v85, v[156:159] offset:12496
    s_mov_b64 exec, 1
    v_cvt_pk_bf16_f32 v161, v224, 0
    v_cvt_pk_bf16_f32 v162, v225, v224
    v_cvt_pk_bf16_f32 v160, v226, v225
    ds_write_b32 v85, v161 offset:4192
    ds_write_b32 v85, v162 offset:8352
    ds_write_b64 v85, v[160:161] offset:12512
    s_mov_b64 exec, -1
    s_branch L_kdone
L_kz1:
    ds_read_b128 v[128:131], v84 offset:256
    ds_read_b128 v[132:135], v80 offset:256
    ds_read_b128 v[148:151], v84 offset:320
    ds_read_b128 v[152:155], v80 offset:320
    ds_read_b128 v[168:171], v84 offset:384
    ds_read_b128 v[172:175], v80 offset:384
    ds_read_b32 v8, v92 offset:0
    ds_read_b128 v[188:191], v84 offset:448
    s_waitcnt lgkmcnt(6)
    v_mfma_f32_16x16x32_bf16 v[224:227], v[132:135], v[128:131], 0
    ds_read_b128 v[192:195], v80 offset:448
    s_waitcnt lgkmcnt(2)
    v_cmp_eq_u32 vcc, 0, v8
    s_cbranch_vccnz R_fa1
B_fa1:
    ds_read_b128 v[128:131], v84 offset:0
    v_mfma_f32_16x16x32_bf16 v[224:227], v[152:155], v[148:151], v[224:227]
    ds_read_b128 v[132:135], v80 offset:0
    ds_read_b128 v[148:151], v84 offset:64
    ds_write_b32 v91, v91 offset:80
    v_mfma_f32_16x16x32_bf16 v[224:227], v[172:175], v[168:171], v[224:227]
    ds_read_b128 v[152:155], v80 offset:64
    ds_read_b128 v[168:171], v84 offset:128
    s_waitcnt lgkmcnt(6)
    v_mfma_f32_16x16x32_bf16 v[224:227], v[192:195], v[188:191], v[224:227]
    ds_read_b128 v[172:175], v80 offset:128
    ds_read_b128 v[188:191], v84 offset:192
    s_waitcnt lgkmcnt(6)
    v_mfma_f32_16x16x32_bf16 v[224:227], v[132:135], v[128:131], v[224:227]
    ds_read_b128 v[192:195], v80 offset:192
    s_waitcnt lgkmcnt(4)
    v_mfma_f32_16x16x32_bf16 v[224:227], v[152:155], v[148:151], v[224:227]
    s_waitcnt lgkmcnt(2)
    v_mfma_f32_16x16x32_bf16 v[224:227], v[172:175], v[168:171], v[224:227]
    s_waitcnt lgkmcnt(0)
    v_mfma_f32_16x16x32_bf16 v[224:227], v[192:195], v[188:191], v[224:227]
    s_nop 7
    v_cvt_pk_bf16_f32 v128, v226, v226
    v_cvt_pk_bf16_f32 v129, v226, v226
    v_cvt_pk_bf16_f32 v130, v225, v225
    v_cvt_pk_bf16_f32 v131, v225, v225
    ds_write_b128 v85, v[128:131] offset:0
    v_cvt_pk_bf16_f32 v132, v225, v225
    v_cvt_pk_bf16_f32 v133, v225, v224
    v_cvt_pk_bf16_f32 v134, v224, v224
    v_cvt_pk_bf16_f32 v135, v224, v224
    ds_write_b128 v85, v[132:135] offset:16
    v_cvt_pk_bf16_f32 v136, v226, v226
    v_cvt_pk_bf16_f32 v137, v226, v226
    v_cvt_pk_bf16_f32 v138, v226, v225
    v_cvt_pk_bf16_f32 v139, v225, v225
    ds_write_b128 v85, v[136:139] offset:4160
    v_cvt_pk_bf16_f32 v140, v225, v225
    v_cvt_pk_bf16_f32 v141, v225, v225
    v_cvt_pk_bf16_f32 v142, v224, v224
    v_cvt_pk_bf16_f32 v143, v224, v224
    ds_write_b128 v85, v[140:143] offset:4176
    v_cvt_pk_bf16_f32 v144, v226, v226
    v_cvt_pk_bf16_f32 v145, v226, v226
    v_cvt_pk_bf16_f32 v146, v226, v226
    v_cvt_pk_bf16_f32 v147, v225, v225
    ds_write_b128 v85, v[144:147] offset:8320
    v_cvt_pk_bf16_f32 v148, v225, v225
    v_cvt_pk_bf16_f32 v149, v225, v225
    v_cvt_pk_bf16_f32 v150, v225, v224
    v_cvt_pk_bf16_f32 v151, v224, v224
    ds_write_b128 v85, v[148:151] offset:8336
    v_cvt_pk_bf16_f32 v152, v226, v226
    v_cvt_pk_bf16_f32 v153, v226, v226
    v_cvt_pk_bf16_f32 v154, v226, v226
    v_cvt_pk_bf16_f32 v155, v226, v225
    ds_write_b128 v85, v[152:155] offset:12480
    v_cvt_pk_bf16_f32 v156, v225, v225
    v_cvt_pk_bf16_f32 v157, v225, v225
    v_cvt_pk_bf16_f32 v158, v225, v225
    v_cvt_pk_bf16_f32 v159, v224, v224
    ds_write_b128 v85, v[156:159] offset:12496
L_kdone:
    v_and_b32 v6, 15, v1
    v_lshrrev_b32 v7, 4, v1
    s_mul_i32 s66, s29, 16640
    s_movk_i32 s67, 4160
    s_lshl_b32 s65, s30, 8
    s_sub_u32 s64, s66, s65
    s_add_u32 s64, s64, 288
    v_add_u32 v8, 1, v6
    v_and_b32 v9, 3, v8
    v_and_b32 v8, 28, v8
    v_lshlrev_b32 v8, 1, v8
    v_lshl_add_u32 v86, v7, 4, s64
    v_sub_u32 v86, v86, v8
    v_mad_u32_u24 v86, v9, s67, v86
    s_mul_i32 s64, s29, 4576
    s_sub_u32 s64, s64, s65
    s_add_u32 s64, s64, 33536
    v_lshl_add_u32 v87, v7, 4, s64
    v_lshl_add_u32 v87, v6, 5, v87
    v_lshl_add_u32 v8, v7, 2, v6
    v_and_b32 v8, 15, v8
    v_lshl_add_u32 v8, v7, 4, v8
    s_lshl_b32 s65, s30, 13
    s_add_u32 s64, s66, s65
    v_lshl_add_u32 v90, v8, 4, s64
    s_waitcnt lgkmcnt(0)
    s_barrier
    ds_read_b64 v[128:129], v86 offset:3776
    ds_read_b64 v[130:131], v86 offset:3784
    ds_read_b128 v[160:163], v87 offset:192
    ds_read_b64 v[132:133], v86 offset:3264
    ds_read_b64 v[134:135], v86 offset:3272
    ds_read_b128 v[164:167], v87 offset:704
    ds_read_b64 v[136:137], v86 offset:2752
    ds_read_b64 v[138:139], v86 offset:2760
    ds_read_b128 v[168:171], v87 offset:1216
    ds_read_b64 v[140:141], v86 offset:2240
    ds_read_b64 v[142:143], v86 offset:2248
    ds_read_b128 v[172:175], v87 offset:1728
    s_waitcnt lgkmcnt(9)
    v_mfma_f32_16x16x32_bf16 v[224:227], v[128:131], v[160:163], 0
    ds_read_b64 v[144:145], v86 offset:1728
    s_waitcnt lgkmcnt(7)
    v_mfma_f32_16x16x32_bf16 v[228:231], v[132:135], v[160:163], 0
    ds_read_b64 v[146:147], v86 offset:1736
    v_mfma_f32_16x16x32_bf16 v[232:235], v[132:135], v[164:167], 0
    ds_read_b128 v[176:179], v87 offset:2240
    v_mfma_f32_16x16x32_bf16 v[228:231], v[128:131], v[164:167], v[228:231]
    ds_read_b64 v[148:149], v86 offset:1216
    s_waitcnt lgkmcnt(7)
    v_mfma_f32_16x16x32_bf16 v[232:235], v[136:139], v[160:163], v[232:235]
    ds_read_b64 v[150:151], v86 offset:1224
    v_mfma_f32_16x16x32_bf16 v[236:239], v[136:139], v[164:167], 0
    ds_read_b128 v[180:183], v87 offset:2752
    v_mfma_f32_16x16x32_bf16 v[240:243], v[136:139], v[168:171], 0
    ds_read_b64 v[152:153], v86 offset:704
    v_mfma_f32_16x16x32_bf16 v[232:235], v[128:131], v[168:171], v[232:235]
    ds_read_b64 v[154:155], v86 offset:712
    v_mfma_f32_16x16x32_bf16 v[236:239], v[132:135], v[168:171], v[236:239]
    ds_read_b128 v[184:187], v87 offset:3264
    s_waitcnt lgkmcnt(9)
    v_mfma_f32_16x16x32_bf16 v[236:239], v[140:143], v[160:163], v[236:239]
    ds_read_b64 v[156:157], v86 offset:192
    v_mfma_f32_16x16x32_bf16 v[240:243], v[140:143], v[164:167], v[240:243]
    ds_read_b64 v[158:159], v86 offset:200
    v_mfma_f32_16x16x32_bf16 v[244:247], v[140:143], v[168:171], 0
    ds_read_b128 v[188:191], v87 offset:3776
    v_mfma_f32_16x16x32_bf16 v[248:251], v[140:143], v[172:175], 0
    ds_read_b64 v[192:193], v86 offset:3712
    v_mfma_f32_16x16x32_bf16 v[236:239], v[128:131], v[172:175], v[236:239]
    ds_read_b64 v[194:195], v86 offset:3720
    v_mfma_f32_16x16x32_bf16 v[240:243], v[132:135], v[172:175], v[240:243]
    ds_read_b128 v[96:99], v87 offset:128
    v_mfma_f32_16x16x32_bf16 v[244:247], v[136:139], v[172:175], v[244:247]
    ds_read_b64 v[196:197], v86 offset:3200
    s_waitcnt lgkmcnt(13)
    v_mfma_f32_16x16x32_bf16 v[240:243], v[144:147], v[160:163], v[240:243]
    ds_read_b64 v[198:199], v86 offset:3208
    v_mfma_f32_16x16x32_bf16 v[244:247], v[144:147], v[164:167], v[244:247]
    ds_read_b128 v[100:103], v87 offset:640
    v_mfma_f32_16x16x32_bf16 v[248:251], v[144:147], v[168:171], v[248:251]
    ds_read_b64 v[200:201], v86 offset:2688
    v_mfma_f32_16x16x32_bf16 v[252:255], v[144:147], v[172:175], 0
    ds_read_b64 v[202:203], v86 offset:2696
    v_mfma_f32_16x16x32_bf16 v[240:243], v[128:131], v[176:179], v[240:243]
    ds_read_b128 v[104:107], v87 offset:1152
    v_mfma_f32_16x16x32_bf16 v[244:247], v[132:135], v[176:179], v[244:247]
    ds_read_b64 v[204:205], v86 offset:2176
    v_mfma_f32_16x16x32_bf16 v[248:251], v[136:139], v[176:179], v[248:251]
    ds_read_b64 v[206:207], v86 offset:2184
    v_mfma_f32_16x16x32_bf16 v[252:255], v[140:143], v[176:179], v[252:255]
    ds_read_b128 v[108:111], v87 offset:1664
    s_waitcnt lgkmcnt(15)
    v_mfma_f32_16x16x32_bf16 v[244:247], v[148:151], v[160:163], v[244:247]
    ds_read_b64 v[208:209], v86 offset:1664
    v_mfma_f32_16x16x32_bf16 v[248:251], v[148:151], v[164:167], v[248:251]
    ds_read_b64 v[210:211], v86 offset:1672
    v_mfma_f32_16x16x32_bf16 v[252:255], v[148:151], v[168:171], v[252:255]
    ds_read_b128 v[112:115], v87 offset:2176
    v_mfma_f32_16x16x32_bf16 v[244:247], v[128:131], v[180:183], v[244:247]
    ds_read_b64 v[212:213], v86 offset:1152
    v_mfma_f32_16x16x32_bf16 v[248:251], v[132:135], v[180:183], v[248:251]
    ds_read_b64 v[214:215], v86 offset:1160
    v_mfma_f32_16x16x32_bf16 v[252:255], v[136:139], v[180:183], v[252:255]
    ds_read_b128 v[116:119], v87 offset:2688
    s_waitcnt lgkmcnt(15)
    v_mfma_f32_16x16x32_bf16 v[248:251], v[152:155], v[160:163], v[248:251]
    ds_read_b64 v[216:217], v86 offset:640
    v_mfma_f32_16x16x32_bf16 v[252:255], v[152:155], v[164:167], v[252:255]
    ds_read_b64 v[218:219], v86 offset:648
    v_mfma_f32_16x16x32_bf16 v[248:251], v[128:131], v[184:187], v[248:251]
    ds_read_b128 v[120:123], v87 offset:3200
    v_mfma_f32_16x16x32_bf16 v[252:255], v[132:135], v[184:187], v[252:255]
    ds_read_b64 v[220:221], v86 offset:128
    s_waitcnt lgkmcnt(15)
    v_mfma_f32_16x16x32_bf16 v[252:255], v[156:159], v[160:163], v[252:255]
    ds_read_b64 v[222:223], v86 offset:136
    v_mfma_f32_16x16x32_bf16 v[252:255], v[128:131], v[188:191], v[252:255]
    ds_read_b128 v[124:127], v87 offset:3712
    s_waitcnt lgkmcnt(12)
    v_mfma_f32_16x16x32_bf16 v[224:227], v[192:195], v[96:99], v[224:227]
    ds_read_b64 v[128:129], v86 offset:3648
    v_lshrrev_b32 v8, 2, v1
    v_mfma_f32_16x16x32_bf16 v[228:231], v[196:199], v[96:99], v[228:231]
    ds_read_b64 v[130:131], v86 offset:3656
    v_and_b32 v9, 3, v1
    v_mfma_f32_16x16x32_bf16 v[232:235], v[196:199], v[100:103], v[232:235]
    ds_read_b128 v[160:163], v87 offset:64
    v_lshlrev_b32 v9, 3, v9
    v_mfma_f32_16x16x32_bf16 v[228:231], v[192:195], v[100:103], v[228:231]
    ds_read_b64 v[132:133], v86 offset:3136
    v_lshl_add_u32 v28, v8, 7, v9
    v_mfma_f32_16x16x32_bf16 v[232:235], v[200:203], v[96:99], v[232:235]
    ds_read_b64 v[134:135], v86 offset:3144
    v_mul_u32_u24 v8, 96, v8
    v_mfma_f32_16x16x32_bf16 v[236:239], v[200:203], v[100:103], v[236:239]
    ds_read_b128 v[164:167], v87 offset:576
    v_add_u32 v8, v8, v9
    v_mfma_f32_16x16x32_bf16 v[240:243], v[200:203], v[104:107], v[240:243]
    ds_read_b64 v[136:137], v86 offset:2624
    v_add_u32 v18, 47872, v8
    v_mfma_f32_16x16x32_bf16 v[232:235], v[192:195], v[104:107], v[232:235]
    ds_read_b64 v[138:139], v86 offset:2632
    v_add_u32 v19, 150272, v8
    v_mfma_f32_16x16x32_bf16 v[236:239], v[196:199], v[104:107], v[236:239]
    ds_read_b128 v[168:171], v87 offset:1088
    v_and_b32 v8, 24, v1
    v_mfma_f32_16x16x32_bf16 v[236:239], v[204:207], v[96:99], v[236:239]
    ds_read_b64 v[140:141], v86 offset:2112
    v_lshl_add_u32 v28, v8, 2, v28
    v_mfma_f32_16x16x32_bf16 v[240:243], v[204:207], v[100:103], v[240:243]
    ds_read_b64 v[142:143], v86 offset:2120
    v_add_u32 v28, 84736, v28
    v_mfma_f32_16x16x32_bf16 v[244:247], v[204:207], v[104:107], v[244:247]
    ds_read_b128 v[172:175], v87 offset:1600
    v_xor_b32 v29, 32, v28
    v_mfma_f32_16x16x32_bf16 v[248:251], v[204:207], v[108:111], v[248:251]
    ds_read_b64 v[144:145], v86 offset:1600
    v_xor_b32 v30, 64, v28
    v_mfma_f32_16x16x32_bf16 v[236:239], v[192:195], v[108:111], v[236:239]
    ds_read_b64 v[146:147], v86 offset:1608
    v_xor_b32 v31, 96, v28
    v_mfma_f32_16x16x32_bf16 v[240:243], v[196:199], v[108:111], v[240:243]
    ds_read_b128 v[176:179], v87 offset:2112
    s_lshl_b32 s64, s24, 5
    v_mfma_f32_16x16x32_bf16 v[244:247], v[200:203], v[108:111], v[244:247]
    ds_read_b64 v[148:149], v86 offset:1088
    v_xor_b32 v49, s64, v28
    s_waitcnt lgkmcnt(15)
    v_mfma_f32_16x16x32_bf16 v[240:243], v[208:211], v[96:99], v[240:243]
    ds_read_b64 v[150:151], v86 offset:1096
    v_add_u32 v50, s64, v18
    v_mfma_f32_16x16x32_bf16 v[244:247], v[208:211], v[100:103], v[244:247]
    ds_read_b128 v[180:183], v87 offset:2624
    v_add_u32 v51, s64, v19
    v_mfma_f32_16x16x32_bf16 v[248:251], v[208:211], v[104:107], v[248:251]
    ds_read_b64 v[152:153], v86 offset:576
    s_lshl1_add_u32 s64, s64, 162560
    v_mfma_f32_16x16x32_bf16 v[252:255], v[208:211], v[108:111], v[252:255]
    ds_read_b64 v[154:155], v86 offset:584
    v_add_u32 v48, s64, v1
    v_mfma_f32_16x16x32_bf16 v[240:243], v[192:195], v[112:115], v[240:243]
    ds_read_b128 v[184:187], v87 offset:3136
    v_mov_b32 v44, 0x3f803f80
    v_mfma_f32_16x16x32_bf16 v[244:247], v[196:199], v[112:115], v[244:247]
    ds_read_b64 v[156:157], v86 offset:64
    v_mov_b32 v45, 0x3f803f80
    v_mfma_f32_16x16x32_bf16 v[248:251], v[200:203], v[112:115], v[248:251]
    ds_read_b64 v[158:159], v86 offset:72
    v_mov_b32 v46, 0x3f803f80
    v_mfma_f32_16x16x32_bf16 v[252:255], v[204:207], v[112:115], v[252:255]
    ds_read_b128 v[188:191], v87 offset:3648
    v_mov_b32 v47, 0x3f803f80
    v_mfma_f32_16x16x32_bf16 v[244:247], v[212:215], v[96:99], v[244:247]
    v_mov_b32 v20, v91
    v_lshlrev_b32 v3, 4, v1
    v_mfma_f32_16x16x32_bf16 v[248:251], v[212:215], v[100:103], v[248:251]
    v_add_u32 v2, 0x1000, v3
    s_mov_b32 s6, 0x10000000
    v_mfma_f32_16x16x32_bf16 v[252:255], v[212:215], v[104:107], v[252:255]
    s_mov_b32 s7, 0x20000
    s_mov_b32 s14, 0x1c0000
    v_mfma_f32_16x16x32_bf16 v[244:247], v[192:195], v[116:119], v[244:247]
    s_mov_b32 s15, 0x20000
    s_mov_b32 s18, 0x1c0000
    v_mfma_f32_16x16x32_bf16 v[248:251], v[196:199], v[116:119], v[248:251]
    s_mov_b32 s19, 0x20000
    s_mov_b32 s22, 0x200000
    v_mfma_f32_16x16x32_bf16 v[252:255], v[200:203], v[116:119], v[252:255]
    s_mov_b32 s23, 0x20000
    s_mov_b32 s28, 0x40000
    v_mfma_f32_16x16x32_bf16 v[248:251], v[216:219], v[96:99], v[248:251]
    s_lshr_b32 s64, s26, 2
    s_add_u32 s32, s64, s26
    v_mfma_f32_16x16x32_bf16 v[252:255], v[216:219], v[100:103], v[252:255]
    s_and_b32 s32, s32, 3
    s_and_b32 s65, s25, 1
    v_mfma_f32_16x16x32_bf16 v[248:251], v[192:195], v[120:123], v[248:251]
    s_lshl_b32 s65, s65, 3
    s_add_u32 s64, s64, s65
    v_mfma_f32_16x16x32_bf16 v[252:255], v[196:199], v[120:123], v[252:255]
    s_lshl_b32 s64, s64, 2
    s_add_u32 s60, s64, s24
    v_mfma_f32_16x16x32_bf16 v[252:255], v[220:223], v[96:99], v[252:255]
    s_lshr_b32 s35, s25, 1
    s_and_b32 s63, s26, 3
    v_mfma_f32_16x16x32_bf16 v[252:255], v[192:195], v[124:127], v[252:255]
    s_lshl_b32 s64, s35, 2
    s_add_u32 s33, s64, s63
    s_waitcnt lgkmcnt(12)
    v_mfma_f32_16x16x32_bf16 v[224:227], v[128:131], v[160:163], v[224:227]
    ds_read_b64 v[192:193], v86 offset:3584
    s_lshl_b32 s34, s24, 10
    v_mfma_f32_16x16x32_bf16 v[228:231], v[132:135], v[160:163], v[228:231]
    ds_read_b64 v[194:195], v86 offset:3592
    s_lshl_b32 s66, s60, 4
    v_mfma_f32_16x16x32_bf16 v[232:235], v[132:135], v[164:167], v[232:235]
    ds_read_b128 v[96:99], v87 offset:0
    s_add_u32 s64, s66, s33
    v_mfma_f32_16x16x32_bf16 v[228:231], v[128:131], v[164:167], v[228:231]
    ds_read_b64 v[196:197], v86 offset:3072
    s_mul_i32 s31, s64, 7168
    v_mfma_f32_16x16x32_bf16 v[232:235], v[136:139], v[160:163], v[232:235]
    ds_read_b64 v[198:199], v86 offset:3080
    s_add_u32 s31, s31, 0x340000
    v_mfma_f32_16x16x32_bf16 v[236:239], v[136:139], v[164:167], v[236:239]
    ds_read_b128 v[100:103], v87 offset:512
    s_add_u32 s27, s27, 0x1739b9
    v_mfma_f32_16x16x32_bf16 v[240:243], v[136:139], v[168:171], v[240:243]
    ds_read_b64 v[200:201], v86 offset:2560
    s_or_b32 s27, s27, 0xffc00000
    v_mfma_f32_16x16x32_bf16 v[232:235], v[128:131], v[168:171], v[232:235]
    ds_read_b64 v[202:203], v86 offset:2568
    s_lshl_b32 s65, s60, 15
    v_mfma_f32_16x16x32_bf16 v[236:239], v[132:135], v[168:171], v[236:239]
    ds_read_b128 v[104:107], v87 offset:1024
    s_add_u32 s65, s65, 0x100000
    v_mfma_f32_16x16x32_bf16 v[236:239], v[140:143], v[160:163], v[236:239]
    ds_read_b64 v[204:205], v86 offset:2048
    s_lshr_b32 s66, s26, 2
    v_mfma_f32_16x16x32_bf16 v[240:243], v[140:143], v[164:167], v[240:243]
    ds_read_b64 v[206:207], v86 offset:2056
    s_add_u32 s64, s66, 0
    v_mfma_f32_16x16x32_bf16 v[244:247], v[140:143], v[168:171], v[244:247]
    ds_read_b128 v[108:111], v87 offset:1536
    s_and_b32 s64, s64, 3
    v_mfma_f32_16x16x32_bf16 v[248:251], v[140:143], v[172:175], v[248:251]
    ds_read_b64 v[208:209], v86 offset:1536
    s_lshl_b32 s64, s64, 13
    v_mfma_f32_16x16x32_bf16 v[236:239], v[128:131], v[172:175], v[236:239]
    ds_read_b64 v[210:211], v86 offset:1544
    s_add_u32 s8, s64, s65
    v_mfma_f32_16x16x32_bf16 v[240:243], v[132:135], v[172:175], v[240:243]
    ds_read_b128 v[112:115], v87 offset:2048
    s_add_u32 s64, s66, 1
    v_mfma_f32_16x16x32_bf16 v[244:247], v[136:139], v[172:175], v[244:247]
    ds_read_b64 v[212:213], v86 offset:1024
    s_and_b32 s64, s64, 3
    s_waitcnt lgkmcnt(15)
    v_mfma_f32_16x16x32_bf16 v[240:243], v[144:147], v[160:163], v[240:243]
    ds_read_b64 v[214:215], v86 offset:1032
    s_lshl_b32 s64, s64, 13
    v_mfma_f32_16x16x32_bf16 v[244:247], v[144:147], v[164:167], v[244:247]
    ds_read_b128 v[116:119], v87 offset:2560
    s_add_u32 s9, s64, s65
    v_mfma_f32_16x16x32_bf16 v[248:251], v[144:147], v[168:171], v[248:251]
    ds_read_b64 v[216:217], v86 offset:512
    s_add_u32 s64, s66, 2
    v_mfma_f32_16x16x32_bf16 v[252:255], v[144:147], v[172:175], v[252:255]
    ds_read_b64 v[218:219], v86 offset:520
    s_and_b32 s64, s64, 3
    v_mfma_f32_16x16x32_bf16 v[240:243], v[128:131], v[176:179], v[240:243]
    ds_read_b128 v[120:123], v87 offset:3072
    s_lshl_b32 s64, s64, 13
    v_mfma_f32_16x16x32_bf16 v[244:247], v[132:135], v[176:179], v[244:247]
    ds_read_b64 v[220:221], v86 offset:0
    s_add_u32 s10, s64, s65
    v_mfma_f32_16x16x32_bf16 v[248:251], v[136:139], v[176:179], v[248:251]
    ds_read_b64 v[222:223], v86 offset:8
    s_add_u32 s64, s66, 3
    v_mfma_f32_16x16x32_bf16 v[252:255], v[140:143], v[176:179], v[252:255]
    ds_read_b128 v[124:127], v87 offset:3584
    s_and_b32 s64, s64, 3
    v_mfma_f32_16x16x32_bf16 v[244:247], v[148:151], v[160:163], v[244:247]
    s_lshl_b32 s64, s64, 13
    s_add_u32 s11, s64, s65
    v_mfma_f32_16x16x32_bf16 v[248:251], v[148:151], v[164:167], v[248:251]
    s_lshl_b32 s66, s60, 4
    s_lshl_b32 s65, s32, 2
    v_mfma_f32_16x16x32_bf16 v[252:255], v[148:151], v[168:171], v[252:255]
    s_add_u32 s66, s66, s65
    s_add_u32 s66, s66, s35
    v_mfma_f32_16x16x32_bf16 v[244:247], v[128:131], v[180:183], v[244:247]
    s_xor_b32 s64, s66, 1
    s_mul_i32 s64, s64, 6144
    v_mfma_f32_16x16x32_bf16 v[248:251], v[132:135], v[180:183], v[248:251]
    s_add_u32 s41, s64, 0xa40000
    s_xor_b32 s64, s66, 2
    v_mfma_f32_16x16x32_bf16 v[252:255], v[136:139], v[180:183], v[252:255]
    s_mul_i32 s64, s64, 6144
    s_add_u32 s42, s64, 0xa40800
    v_mfma_f32_16x16x32_bf16 v[248:251], v[152:155], v[160:163], v[248:251]
    s_xor_b32 s64, s66, 3
    s_mul_i32 s64, s64, 6144
    v_mfma_f32_16x16x32_bf16 v[252:255], v[152:155], v[164:167], v[252:255]
    s_add_u32 s43, s64, 0xa41000
    s_mul_i32 s64, s66, 6144
    v_mfma_f32_16x16x32_bf16 v[248:251], v[128:131], v[184:187], v[248:251]
    s_add_u32 s44, s64, 0xa40000
    s_add_u32 s45, s64, 0xa40800
    v_mfma_f32_16x16x32_bf16 v[252:255], v[132:135], v[184:187], v[252:255]
    s_add_u32 s46, s64, 0xa41000
    s_and_b32 s64, s66, 15
    v_mfma_f32_16x16x32_bf16 v[252:255], v[156:159], v[160:163], v[252:255]
    s_lshl_b32 s64, s64, 6
    s_lshl_b32 s65, s60, 15
    v_mfma_f32_16x16x32_bf16 v[252:255], v[128:131], v[188:191], v[252:255]
    s_add_u32 s47, s64, s65
    s_lshl_b32 s66, s60, 4
    s_waitcnt lgkmcnt(0)
    ds_write_b32 v91, v91 offset:16
    v_mfma_f32_16x16x32_bf16 v[224:227], v[192:195], v[96:99], v[224:227]
    s_add_u32 s66, s66, s33
    s_xor_b32 s64, s66, 1
    v_mfma_f32_16x16x32_bf16 v[228:231], v[192:195], v[100:103], v[228:231]
    s_mul_i32 s64, s64, 7168
    s_add_u32 s37, s64, 0x340000
    v_mfma_f32_16x16x32_bf16 v[228:231], v[196:199], v[96:99], v[228:231]
    ds_read_b32 v93, v92 offset:16
    s_xor_b32 s64, s66, 2
    s_mul_i32 s64, s64, 7168
    v_mfma_f32_16x16x32_bf16 v[232:235], v[192:195], v[104:107], v[232:235]
    s_add_u32 s38, s64, 0x340000
    s_xor_b32 s64, s66, 3
    v_mfma_f32_16x16x32_bf16 v[232:235], v[196:199], v[100:103], v[232:235]
    s_mul_i32 s64, s64, 7168
    s_add_u32 s39, s64, 0x340000
    v_mfma_f32_16x16x32_bf16 v[232:235], v[200:203], v[96:99], v[232:235]
    s_mov_b32 s52, 0x70000000
    s_mov_b32 s48, 0x00010001
    v_mfma_f32_16x16x32_bf16 v[236:239], v[192:195], v[108:111], v[236:239]
    s_waitcnt lgkmcnt(0)
    v_cmp_eq_u32 vcc, 0, v93
    s_mov_b32 s49, 0x10000
    s_mov_b32 s50, 0x07060302
    v_mfma_f32_16x16x32_bf16 v[236:239], v[196:199], v[104:107], v[236:239]
    s_cbranch_vccnz R_fc
B_fc:
    v_bfe_u32 v8, v1, 2, 2
    v_mul_u32_u24 v27, 320, v8
    v_mfma_f32_16x16x32_bf16 v[236:239], v[200:203], v[100:103], v[236:239]
    ds_write_b128 v90, v[224:227] offset:0
    v_lshrrev_b32 v8, 5, v1
    v_mfma_f32_16x16x32_bf16 v[236:239], v[204:207], v[96:99], v[236:239]
    v_lshl_add_u32 v27, v8, 11, v27
    v_bfe_u32 v8, v1, 4, 1
    v_mfma_f32_16x16x32_bf16 v[240:243], v[192:195], v[112:115], v[240:243]
    ds_write_b128 v90, v[228:231] offset:1024
    v_lshl_add_u32 v27, v8, 5, v27
    v_mfma_f32_16x16x32_bf16 v[240:243], v[196:199], v[108:111], v[240:243]
    v_and_b32 v8, 1, v1
    v_lshl_add_u32 v27, v8, 4, v27
    v_mfma_f32_16x16x32_bf16 v[240:243], v[200:203], v[104:107], v[240:243]
    v_bfe_u32 v8, v1, 1, 1
    v_lshl_add_u32 v27, v8, 3, v27
    v_mfma_f32_16x16x32_bf16 v[240:243], v[204:207], v[100:103], v[240:243]
    ds_write_b128 v90, v[232:235] offset:2048
    v_add_u32 v27, 19200, v27
    v_mfma_f32_16x16x32_bf16 v[240:243], v[208:211], v[96:99], v[240:243]
    v_and_b32 v8, 15, v1
    v_lshrrev_b32 v9, 4, v1
    v_mfma_f32_16x16x32_bf16 v[244:247], v[192:195], v[116:119], v[244:247]
    v_lshlrev_b32 v24, 4, v9
    v_add_u32 v24, 162560, v24
    v_mfma_f32_16x16x32_bf16 v[244:247], v[196:199], v[112:115], v[244:247]
    s_mul_i32 s64, s24, 4608
    v_mul_u32_u24 v25, 288, v8
    v_mfma_f32_16x16x32_bf16 v[244:247], v[200:203], v[108:111], v[244:247]
    ds_write_b128 v90, v[236:239] offset:3072
    v_add_u32 v25, s64, v25
    v_mfma_f32_16x16x32_bf16 v[244:247], v[204:207], v[104:107], v[244:247]
    v_and_b32 v5, 1, v9
    v_mul_u32_u24 v5, 144, v5
    v_mfma_f32_16x16x32_bf16 v[244:247], v[208:211], v[100:103], v[244:247]
    v_lshrrev_b32 v6, 1, v9
    v_lshl_add_u32 v5, v6, 5, v5
    v_mfma_f32_16x16x32_bf16 v[244:247], v[212:215], v[96:99], v[244:247]
    v_add_u32 v5, v5, v25
    v_and_b32 v7, 1, v9
    v_mfma_f32_16x16x32_bf16 v[248:251], v[192:195], v[120:123], v[248:251]
    v_lshlrev_b32 v22, 10, v7
    v_lshl_add_u32 v22, v6, 8, v22
    v_mfma_f32_16x16x32_bf16 v[248:251], v[196:199], v[116:119], v[248:251]
    ds_write_b128 v90, v[240:243] offset:4096
    v_lshl_add_u32 v22, v8, 3, v22
    v_mfma_f32_16x16x32_bf16 v[248:251], v[200:203], v[112:115], v[248:251]
    v_add_u32 v23, 0x1000, v22
    v_mov_b32 v4, 0xeeee4444
    v_mfma_f32_16x16x32_bf16 v[248:251], v[204:207], v[108:111], v[248:251]
    v_and_b32 v26, 3, v1
    v_lshlrev_b32 v26, 2, v26
    v_mfma_f32_16x16x32_bf16 v[248:251], v[208:211], v[104:107], v[248:251]
    v_add_u32 v26, 163824, v26
    v_bfe_u32 v0, v1, 0, 4
    v_mfma_f32_16x16x32_bf16 v[248:251], v[212:215], v[100:103], v[248:251]
    v_bfe_u32 v8, v1, 4, 2
    v_add3_u32 v0, v0, v8, 1
    v_mfma_f32_16x16x32_bf16 v[248:251], v[216:219], v[96:99], v[248:251]
    v_bfe_u32 v0, s27, v0, 1
    s_and_b32 s64, s27, 1
    v_mfma_f32_16x16x32_bf16 v[252:255], v[192:195], v[124:127], v[252:255]
    ds_write_b128 v90, v[244:247] offset:5120
    v_lshl_or_b32 v0, v0, 16, s64
    v_mfma_f32_16x16x32_bf16 v[252:255], v[196:199], v[120:123], v[252:255]
    v_xor_b32 v7, s48, v0
    s_and_b32 s64, s3, 0xfc
    v_mfma_f32_16x16x32_bf16 v[252:255], v[200:203], v[116:119], v[252:255]
    s_lshl1_add_u32 s64, s64, s24
    s_lshl2_add_u32 s64, s64, s63
    v_mfma_f32_16x16x32_bf16 v[252:255], v[204:207], v[112:115], v[252:255]
    s_lshl2_add_u32 s53, s64, 0x10000
    v_mov_b32 v6, s27
    v_mfma_f32_16x16x32_bf16 v[252:255], v[208:211], v[108:111], v[252:255]
    v_mov_b32 v14, 0xead2d3e8
    v_mov_b32 v15, 0xcf135761
    v_mfma_f32_16x16x32_bf16 v[252:255], v[212:215], v[104:107], v[252:255]
    v_mov_b32 v16, 0x30800000
    v_mov_b32 v17, 0xc1f00000
    v_mfma_f32_16x16x32_bf16 v[252:255], v[216:219], v[100:103], v[252:255]
    v_xor_b32 v56, 0, v27
    v_add_u32 v60, 57344, v56
    v_mfma_f32_16x16x32_bf16 v[252:255], v[220:223], v[96:99], v[252:255]
    ds_write_b128 v90, v[248:251] offset:6144
    v_xor_b32 v57, 64, v27
    s_nop 5
    ds_write_b128 v90, v[252:255] offset:7168
    s_waitcnt lgkmcnt(0)
    s_barrier
    ds_read_b64_tr_b16 v[96:97], v49 offset:0
    ds_read_b64_tr_b16 v[98:99], v49 offset:2048
    ds_read_b64_tr_b16 v[100:101], v49 offset:4096
    ds_read_b64_tr_b16 v[102:103], v49 offset:6144
    ds_read_b64_tr_b16 v[104:105], v49 offset:8192
    ds_read_b64_tr_b16 v[106:107], v49 offset:10240
    ds_read_b64_tr_b16 v[108:109], v49 offset:12288
    ds_read_b64_tr_b16 v[110:111], v49 offset:14336
    ds_read_b64_tr_b16 v[112:113], v49 offset:16384
    ds_read_b64_tr_b16 v[114:115], v49 offset:18432
    ds_read_b64_tr_b16 v[116:117], v49 offset:20480
    ds_read_b64_tr_b16 v[118:119], v49 offset:22528
    v_add_u32 v61, 57344, v57
    v_xor_b32 v58, 128, v27
    v_add_u32 v62, 57344, v58
    ds_read_b64_tr_b16 v[120:121], v49 offset:24576
    ds_read_b64_tr_b16 v[122:123], v49 offset:26624
    s_waitcnt lgkmcnt(12)
    v_mfma_f32_16x16x32_bf16 v[184:187], v[96:99], v[44:47], 0
    v_xor_b32 v59, 192, v27
    v_add_u32 v63, 57344, v59
    ds_read_b64_tr_b16 v[124:125], v49 offset:28672
    ds_read_b64_tr_b16 v[126:127], v49 offset:30720
    s_waitcnt lgkmcnt(12)
    v_mfma_f32_16x16x32_bf16 v[184:187], v[100:103], v[44:47], v[184:187]
    v_mov_b64 v[128:129], 0
    v_mov_b64 v[130:131], 0
    ds_read_b64_tr_b16 v[96:97], v49 offset:32768
    ds_read_b64_tr_b16 v[98:99], v49 offset:34816
    s_waitcnt lgkmcnt(12)
    v_mfma_f32_16x16x32_bf16 v[184:187], v[104:107], v[44:47], v[184:187]
    v_mov_b64 v[132:133], 0
    v_mov_b64 v[134:135], 0
    ds_read_b64_tr_b16 v[100:101], v49 offset:36864
    ds_read_b64_tr_b16 v[102:103], v49 offset:38912
    s_waitcnt lgkmcnt(12)
    v_mfma_f32_16x16x32_bf16 v[184:187], v[108:111], v[44:47], v[184:187]
    v_mov_b64 v[136:137], 0
    v_mov_b64 v[138:139], 0
    ds_read_b64_tr_b16 v[104:105], v49 offset:40960
    ds_read_b64_tr_b16 v[106:107], v49 offset:43008
    s_waitcnt lgkmcnt(12)
    v_mfma_f32_16x16x32_bf16 v[184:187], v[112:115], v[44:47], v[184:187]
    v_mov_b64 v[140:141], 0
    v_mov_b64 v[142:143], 0
    s_barrier
    ds_read_b64_tr_b16 v[108:109], v49 offset:45056
    ds_read_b64_tr_b16 v[110:111], v49 offset:47104
    s_waitcnt lgkmcnt(12)
    v_mfma_f32_16x16x32_bf16 v[184:187], v[116:119], v[44:47], v[184:187]
    v_mov_b64 v[144:145], 0
    v_mov_b64 v[146:147], 0
    ds_read_b64_tr_b16 v[112:113], v49 offset:49152
    ds_read_b64_tr_b16 v[114:115], v49 offset:51200
    s_waitcnt lgkmcnt(12)
    v_mfma_f32_16x16x32_bf16 v[184:187], v[120:123], v[44:47], v[184:187]
    v_mov_b64 v[148:149], 0
    v_mov_b64 v[150:151], 0
    ds_read_b64_tr_b16 v[116:117], v49 offset:53248
    ds_read_b64_tr_b16 v[118:119], v49 offset:55296
    s_waitcnt lgkmcnt(12)
    v_mfma_f32_16x16x32_bf16 v[184:187], v[124:127], v[44:47], v[184:187]
    v_mov_b64 v[152:153], 0
    v_mov_b64 v[154:155], 0
    ds_read_b64_tr_b16 v[120:121], v49 offset:57344
    ds_read_b64_tr_b16 v[122:123], v49 offset:59392
    s_waitcnt lgkmcnt(12)
    v_mfma_f32_16x16x32_bf16 v[184:187], v[96:99], v[44:47], v[184:187]
    v_mov_b64 v[156:157], 0
    v_mov_b64 v[158:159], 0
    ds_read_b64_tr_b16 v[124:125], v49 offset:61440
    ds_read_b64_tr_b16 v[126:127], v49 offset:63488
    s_waitcnt lgkmcnt(12)
    v_mfma_f32_16x16x32_bf16 v[184:187], v[100:103], v[44:47], v[184:187]
    v_mov_b64 v[160:161], 0
    v_mov_b64 v[162:163], 0
    s_waitcnt lgkmcnt(10)
    v_mfma_f32_16x16x32_bf16 v[184:187], v[104:107], v[44:47], v[184:187]
    v_mov_b64 v[164:165], 0
    v_mov_b64 v[166:167], 0
    s_waitcnt lgkmcnt(8)
    v_mfma_f32_16x16x32_bf16 v[184:187], v[108:111], v[44:47], v[184:187]
    v_mov_b64 v[168:169], 0
    v_mov_b64 v[170:171], 0
    s_waitcnt lgkmcnt(6)
    v_mfma_f32_16x16x32_bf16 v[184:187], v[112:115], v[44:47], v[184:187]
    v_mov_b64 v[172:173], 0
    v_mov_b64 v[174:175], 0
    s_waitcnt lgkmcnt(4)
    v_mfma_f32_16x16x32_bf16 v[184:187], v[116:119], v[44:47], v[184:187]
    v_mov_b64 v[176:177], 0
    v_mov_b64 v[178:179], 0
    s_waitcnt lgkmcnt(2)
    v_mfma_f32_16x16x32_bf16 v[184:187], v[120:123], v[44:47], v[184:187]
    v_mov_b64 v[180:181], 0
    v_mov_b64 v[182:183], 0
    s_waitcnt lgkmcnt(0)
    v_mfma_f32_16x16x32_bf16 v[184:187], v[124:127], v[44:47], v[184:187]
    s_branch L_be
    .p2align 12
L_be:
    s_barrier
    s_setprio 1
    s_cmp_eq_u32 0, 0
L_g1start:
    buffer_load_dwordx2 v[64:65], v22, s[4:7], s8 offen offset:0 sc1
    buffer_load_dwordx2 v[66:67], v22, s[4:7], s8 offen offset:128 sc1
    buffer_load_dwordx2 v[68:69], v22, s[4:7], s8 offen offset:512 sc1
    buffer_load_dwordx2 v[70:71], v22, s[4:7], s8 offen offset:640 sc1
    ds_read_b64_tr_b16 v[96:97], v50 offset:0
    ds_read_b64_tr_b16 v[98:99], v50 offset:1536
    ds_read_b64_tr_b16 v[100:101], v50 offset:3072
    ds_read_b64_tr_b16 v[102:103], v50 offset:4608
    ds_read_b64_tr_b16 v[104:105], v50 offset:6144
    ds_read_b64_tr_b16 v[106:107], v50 offset:7680
    ds_read_b64_tr_b16 v[108:109], v50 offset:9216
    ds_read_b64_tr_b16 v[110:111], v50 offset:10752
    ds_read_b64_tr_b16 v[112:113], v50 offset:12288
    ds_read_b64_tr_b16 v[114:115], v50 offset:13824
    ds_read_b64_tr_b16 v[116:117], v50 offset:15360
    ds_read_b64_tr_b16 v[118:119], v50 offset:16896
    buffer_load_dwordx2 v[72:73], v22, s[4:7], s8 offen offset:2048 sc1
    ds_read_b64_tr_b16 v[120:121], v50 offset:18432
    ds_read_b64_tr_b16 v[122:123], v50 offset:19968
    s_waitcnt lgkmcnt(12)
    v_mfma_f32_16x16x32_bf16 v[188:191], v[96:99], v[44:47], 0
    buffer_load_dwordx2 v[74:75], v22, s[4:7], s8 offen offset:2176 sc1
    ds_read_b64_tr_b16 v[124:125], v50 offset:21504
    ds_read_b64_tr_b16 v[126:127], v50 offset:23040
    s_waitcnt lgkmcnt(12)
    v_mfma_f32_16x16x32_bf16 v[188:191], v[100:103], v[44:47], v[188:191]
    buffer_load_dwordx2 v[76:77], v22, s[4:7], s8 offen offset:2560 sc1
    ds_read_b64_tr_b16 v[96:97], v50 offset:24576
    ds_read_b64_tr_b16 v[98:99], v50 offset:26112
    s_waitcnt lgkmcnt(12)
    v_mfma_f32_16x16x32_bf16 v[188:191], v[104:107], v[44:47], v[188:191]
    buffer_load_dwordx2 v[78:79], v22, s[4:7], s8 offen offset:2688 sc1
    ds_read_b64_tr_b16 v[100:101], v50 offset:27648
    ds_read_b64_tr_b16 v[102:103], v50 offset:29184
    s_waitcnt lgkmcnt(12)
    v_mfma_f32_16x16x32_bf16 v[188:191], v[108:111], v[44:47], v[188:191]
    buffer_load_dwordx2 v[80:81], v23, s[4:7], s8 offen offset:0 sc1
    ds_read_b64_tr_b16 v[104:105], v50 offset:30720
    ds_read_b64_tr_b16 v[106:107], v50 offset:32256
    s_waitcnt lgkmcnt(12)
    v_mfma_f32_16x16x32_bf16 v[188:191], v[112:115], v[44:47], v[188:191]
    buffer_load_dwordx2 v[82:83], v23, s[4:7], s8 offen offset:128 sc1
    ds_read_b64_tr_b16 v[108:109], v50 offset:33792
    ds_read_b64_tr_b16 v[110:111], v50 offset:35328
    s_waitcnt lgkmcnt(12)
    v_mfma_f32_16x16x32_bf16 v[188:191], v[116:119], v[44:47], v[188:191]
    buffer_load_dwordx2 v[84:85], v23, s[4:7], s8 offen offset:512 sc1
    ds_read_b64_tr_b16 v[112:113], v51 offset:0
    ds_read_b64_tr_b16 v[114:115], v51 offset:1536
    s_waitcnt lgkmcnt(12)
    v_mfma_f32_16x16x32_bf16 v[188:191], v[120:123], v[44:47], v[188:191]
    buffer_load_dwordx2 v[86:87], v23, s[4:7], s8 offen offset:640 sc1
    ds_read_b64_tr_b16 v[116:117], v51 offset:3072
    ds_read_b64_tr_b16 v[118:119], v51 offset:4608
    s_waitcnt lgkmcnt(12)
    v_mfma_f32_16x16x32_bf16 v[188:191], v[124:127], v[44:47], v[188:191]
    buffer_load_dwordx2 v[88:89], v23, s[4:7], s8 offen offset:2048 sc1
    ds_read_b64_tr_b16 v[120:121], v51 offset:6144
    ds_read_b64_tr_b16 v[122:123], v51 offset:7680
    s_waitcnt lgkmcnt(12)
    v_mfma_f32_16x16x32_bf16 v[188:191], v[96:99], v[44:47], v[188:191]
    buffer_load_dwordx2 v[90:91], v23, s[4:7], s8 offen offset:2176 sc1
    ds_read_b64_tr_b16 v[124:125], v51 offset:9216
    ds_read_b64_tr_b16 v[126:127], v51 offset:10752
    s_waitcnt lgkmcnt(12)
    v_mfma_f32_16x16x32_bf16 v[188:191], v[100:103], v[44:47], v[188:191]
    buffer_load_dwordx2 v[92:93], v23, s[4:7], s8 offen offset:2560 sc1
    s_waitcnt lgkmcnt(10)
    v_mfma_f32_16x16x32_bf16 v[188:191], v[104:107], v[44:47], v[188:191]
    buffer_load_dwordx2 v[94:95], v23, s[4:7], s8 offen offset:2688 sc1
    s_waitcnt lgkmcnt(8)
    v_mfma_f32_16x16x32_bf16 v[188:191], v[108:111], v[44:47], v[188:191]
    ds_read_b64_tr_b16 v[200:201], v28 offset:0
    ds_read_b64_tr_b16 v[202:203], v28 offset:2048
    ds_read_b64_tr_b16 v[204:205], v29 offset:0
    ds_read_b64_tr_b16 v[206:207], v29 offset:2048
    s_waitcnt lgkmcnt(10)
    v_mfma_f32_16x16x32_bf16 v[188:191], v[112:115], v[44:47], v[188:191]
    ds_read_b64_tr_b16 v[208:209], v30 offset:0
    ds_read_b64_tr_b16 v[210:211], v30 offset:2048
    ds_read_b64_tr_b16 v[212:213], v31 offset:0
    ds_read_b64_tr_b16 v[214:215], v31 offset:2048
    s_waitcnt lgkmcnt(12)
    v_mfma_f32_16x16x32_bf16 v[188:191], v[116:119], v[44:47], v[188:191]
    ds_read_b64_tr_b16 v[216:217], v18 offset:0
    ds_read_b64_tr_b16 v[218:219], v18 offset:1536
    ds_read_b64_tr_b16 v[220:221], v18 offset:32
    ds_read_b64_tr_b16 v[222:223], v18 offset:1568
    s_waitcnt lgkmcnt(14)
    v_mfma_f32_16x16x32_bf16 v[188:191], v[120:123], v[44:47], v[188:191]
    ds_read_b64_tr_b16 v[224:225], v18 offset:64
    ds_read_b64_tr_b16 v[226:227], v18 offset:1600
    s_waitcnt lgkmcnt(14)
    v_mfma_f32_16x16x32_bf16 v[188:191], v[124:127], v[44:47], v[188:191]
    s_mov_b32 exec_lo, 0x00010001
    s_mov_b32 exec_hi, 0x00010001
    ds_write_b128 v48, v[184:187]
    s_nop 4
    ds_write_b128 v48, v[188:191] offset:256
    s_mov_b64 exec, -1
    s_waitcnt vmcnt(12)
    v_max3_f32 v8, |v65|, |v67|, |v69|
    v_max_f32_e64 v8, |v71|, v8
    v_cmp_le_f32 vcc, s52, v8
    s_cbranch_vccnz R_h0
B_h0:
    s_waitcnt lgkmcnt(6)
    v_smfmac_f32_16x16x64_bf16 v[128:131], v[200:203], v[64:71], v4
    buffer_load_dwordx2 v[96:97], v22, s[4:7], s9 offen offset:0 sc1
    v_smfmac_f32_16x16x64_bf16 v[132:135], v[200:203], v[64:71], v4 abid:1
    ds_read_b64_tr_b16 v[228:229], v28 offset:4096
    ds_read_b64_tr_b16 v[230:231], v28 offset:6144
    v_smfmac_f32_16x16x64_bf16 v[136:139], v[204:207], v[64:71], v4
    ds_read_b64_tr_b16 v[232:233], v29 offset:4096
    ds_read_b64_tr_b16 v[234:235], v29 offset:6144
    v_smfmac_f32_16x16x64_bf16 v[140:143], v[204:207], v[64:71], v4 abid:1
    ds_read_b64_tr_b16 v[236:237], v30 offset:4096
    ds_read_b64_tr_b16 v[238:239], v30 offset:6144
    v_smfmac_f32_16x16x64_bf16 v[144:147], v[208:211], v[64:71], v4
    buffer_load_dwordx2 v[98:99], v22, s[4:7], s9 offen offset:128 sc1
    v_smfmac_f32_16x16x64_bf16 v[148:151], v[208:211], v[64:71], v4 abid:1
    ds_read_b64_tr_b16 v[240:241], v31 offset:4096
    s_waitcnt vmcnt(10)
    v_smfmac_f32_16x16x64_bf16 v[152:155], v[212:215], v[64:71], v4
    ds_read_b64_tr_b16 v[242:243], v31 offset:6144
    v_max3_f32 v8, |v73|, |v75|, |v77|
    v_smfmac_f32_16x16x64_bf16 v[156:159], v[212:215], v[64:71], v4 abid:1
    buffer_load_dwordx2 v[100:101], v22, s[4:7], s9 offen offset:512 sc1
    s_waitcnt lgkmcnt(8)
    v_smfmac_f32_16x16x64_bf16 v[160:163], v[216:219], v[64:71], v4
    ds_read_b64_tr_b16 v[244:245], v18 offset:3072
    v_max_f32_e64 v8, |v79|, v8
    v_smfmac_f32_16x16x64_bf16 v[164:167], v[216:219], v[64:71], v4 abid:1
    ds_read_b64_tr_b16 v[246:247], v18 offset:4608
    v_smfmac_f32_16x16x64_bf16 v[168:171], v[220:223], v[64:71], v4
    ds_read_b64_tr_b16 v[248:249], v18 offset:3104
    v_cmp_le_f32 vcc, s52, v8
    v_smfmac_f32_16x16x64_bf16 v[172:175], v[220:223], v[64:71], v4 abid:1
    buffer_load_dwordx2 v[102:103], v22, s[4:7], s9 offen offset:640 sc1
    v_smfmac_f32_16x16x64_bf16 v[176:179], v[224:227], v[64:71], v4
    ds_read_b64_tr_b16 v[250:251], v18 offset:4640
    ds_read_b64_tr_b16 v[252:253], v18 offset:3136
    v_smfmac_f32_16x16x64_bf16 v[180:183], v[224:227], v[64:71], v4 abid:1
    ds_read_b64_tr_b16 v[254:255], v18 offset:4672
    s_cbranch_vccnz R_h1
B_h1:
    s_waitcnt lgkmcnt(6)
    v_smfmac_f32_16x16x64_bf16 v[128:131], v[228:231], v[72:79], v4
    buffer_load_dwordx2 v[104:105], v22, s[4:7], s9 offen offset:2048 sc1
    v_smfmac_f32_16x16x64_bf16 v[132:135], v[228:231], v[72:79], v4 abid:1
    ds_read_b64_tr_b16 v[200:201], v28 offset:8192
    ds_read_b64_tr_b16 v[202:203], v28 offset:10240
    v_smfmac_f32_16x16x64_bf16 v[136:139], v[232:235], v[72:79], v4
    ds_read_b64_tr_b16 v[204:205], v29 offset:8192
    ds_read_b64_tr_b16 v[206:207], v29 offset:10240
    v_smfmac_f32_16x16x64_bf16 v[140:143], v[232:235], v[72:79], v4 abid:1
    ds_read_b64_tr_b16 v[208:209], v30 offset:8192
    ds_read_b64_tr_b16 v[210:211], v30 offset:10240
    v_smfmac_f32_16x16x64_bf16 v[144:147], v[236:239], v[72:79], v4
    buffer_load_dwordx2 v[106:107], v22, s[4:7], s9 offen offset:2176 sc1
    v_smfmac_f32_16x16x64_bf16 v[148:151], v[236:239], v[72:79], v4 abid:1
    ds_read_b64_tr_b16 v[212:213], v31 offset:8192
    s_waitcnt vmcnt(10)
    v_smfmac_f32_16x16x64_bf16 v[152:155], v[240:243], v[72:79], v4
    ds_read_b64_tr_b16 v[214:215], v31 offset:10240
    v_max3_f32 v8, |v81|, |v83|, |v85|
    v_smfmac_f32_16x16x64_bf16 v[156:159], v[240:243], v[72:79], v4 abid:1
    buffer_load_dwordx2 v[108:109], v22, s[4:7], s9 offen offset:2560 sc1
    s_waitcnt lgkmcnt(8)
    v_smfmac_f32_16x16x64_bf16 v[160:163], v[244:247], v[72:79], v4
    ds_read_b64_tr_b16 v[216:217], v18 offset:6144
    v_max_f32_e64 v8, |v87|, v8
    v_smfmac_f32_16x16x64_bf16 v[164:167], v[244:247], v[72:79], v4 abid:1
    ds_read_b64_tr_b16 v[218:219], v18 offset:7680
    v_smfmac_f32_16x16x64_bf16 v[168:171], v[248:251], v[72:79], v4
    ds_read_b64_tr_b16 v[220:221], v18 offset:6176
    v_cmp_le_f32 vcc, s52, v8
    v_smfmac_f32_16x16x64_bf16 v[172:175], v[248:251], v[72:79], v4 abid:1
    buffer_load_dwordx2 v[110:111], v22, s[4:7], s9 offen offset:2688 sc1
    v_smfmac_f32_16x16x64_bf16 v[176:179], v[252:255], v[72:79], v4
    ds_read_b64_tr_b16 v[222:223], v18 offset:7712
    ds_read_b64_tr_b16 v[224:225], v18 offset:6208
    v_smfmac_f32_16x16x64_bf16 v[180:183], v[252:255], v[72:79], v4 abid:1
    ds_read_b64_tr_b16 v[226:227], v18 offset:7744
    s_cbranch_vccnz R_h2
B_h2:
    s_waitcnt lgkmcnt(6)
    v_smfmac_f32_16x16x64_bf16 v[128:131], v[200:203], v[80:87], v4
    buffer_load_dwordx2 v[112:113], v23, s[4:7], s9 offen offset:0 sc1
    v_smfmac_f32_16x16x64_bf16 v[132:135], v[200:203], v[80:87], v4 abid:1
    ds_read_b64_tr_b16 v[228:229], v28 offset:12288
    ds_read_b64_tr_b16 v[230:231], v28 offset:14336
    v_smfmac_f32_16x16x64_bf16 v[136:139], v[204:207], v[80:87], v4
    ds_read_b64_tr_b16 v[232:233], v29 offset:12288
    ds_read_b64_tr_b16 v[234:235], v29 offset:14336
    v_smfmac_f32_16x16x64_bf16 v[140:143], v[204:207], v[80:87], v4 abid:1
    ds_read_b64_tr_b16 v[236:237], v30 offset:12288
    ds_read_b64_tr_b16 v[238:239], v30 offset:14336
    v_smfmac_f32_16x16x64_bf16 v[144:147], v[208:211], v[80:87], v4
    buffer_load_dwordx2 v[114:115], v23, s[4:7], s9 offen offset:128 sc1
    v_smfmac_f32_16x16x64_bf16 v[148:151], v[208:211], v[80:87], v4 abid:1
    ds_read_b64_tr_b16 v[240:241], v31 offset:12288
    s_waitcnt vmcnt(10)
    v_smfmac_f32_16x16x64_bf16 v[152:155], v[212:215], v[80:87], v4
    ds_read_b64_tr_b16 v[242:243], v31 offset:14336
    v_max3_f32 v8, |v89|, |v91|, |v93|
    v_smfmac_f32_16x16x64_bf16 v[156:159], v[212:215], v[80:87], v4 abid:1
    buffer_load_dwordx2 v[116:117], v23, s[4:7], s9 offen offset:512 sc1
    s_waitcnt lgkmcnt(8)
    v_smfmac_f32_16x16x64_bf16 v[160:163], v[216:219], v[80:87], v4
    ds_read_b64_tr_b16 v[244:245], v18 offset:9216
    v_max_f32_e64 v8, |v95|, v8
    v_smfmac_f32_16x16x64_bf16 v[164:167], v[216:219], v[80:87], v4 abid:1
    ds_read_b64_tr_b16 v[246:247], v18 offset:10752
    v_smfmac_f32_16x16x64_bf16 v[168:171], v[220:223], v[80:87], v4
    ds_read_b64_tr_b16 v[248:249], v18 offset:9248
    v_cmp_le_f32 vcc, s52, v8
    v_smfmac_f32_16x16x64_bf16 v[172:175], v[220:223], v[80:87], v4 abid:1
    buffer_load_dwordx2 v[118:119], v23, s[4:7], s9 offen offset:640 sc1
    v_smfmac_f32_16x16x64_bf16 v[176:179], v[224:227], v[80:87], v4
    ds_read_b64_tr_b16 v[250:251], v18 offset:10784
    ds_read_b64_tr_b16 v[252:253], v18 offset:9280
    v_smfmac_f32_16x16x64_bf16 v[180:183], v[224:227], v[80:87], v4 abid:1
    ds_read_b64_tr_b16 v[254:255], v18 offset:10816
    s_cbranch_vccnz R_h3
B_h3:
    s_waitcnt lgkmcnt(6)
    v_smfmac_f32_16x16x64_bf16 v[128:131], v[228:231], v[88:95], v4
    buffer_load_dwordx2 v[120:121], v23, s[4:7], s9 offen offset:2048 sc1
    v_smfmac_f32_16x16x64_bf16 v[132:135], v[228:231], v[88:95], v4 abid:1
    ds_read_b64_tr_b16 v[200:201], v28 offset:16384
    ds_read_b64_tr_b16 v[202:203], v28 offset:18432
    v_smfmac_f32_16x16x64_bf16 v[136:139], v[232:235], v[88:95], v4
    ds_read_b64_tr_b16 v[204:205], v29 offset:16384
    ds_read_b64_tr_b16 v[206:207], v29 offset:18432
    v_smfmac_f32_16x16x64_bf16 v[140:143], v[232:235], v[88:95], v4 abid:1
    ds_read_b64_tr_b16 v[208:209], v30 offset:16384
    ds_read_b64_tr_b16 v[210:211], v30 offset:18432
    v_smfmac_f32_16x16x64_bf16 v[144:147], v[236:239], v[88:95], v4
    buffer_load_dwordx2 v[122:123], v23, s[4:7], s9 offen offset:2176 sc1
    v_smfmac_f32_16x16x64_bf16 v[148:151], v[236:239], v[88:95], v4 abid:1
    ds_read_b64_tr_b16 v[212:213], v31 offset:16384
    v_smfmac_f32_16x16x64_bf16 v[152:155], v[240:243], v[88:95], v4
    ds_read_b64_tr_b16 v[214:215], v31 offset:18432
    v_smfmac_f32_16x16x64_bf16 v[156:159], v[240:243], v[88:95], v4 abid:1
    buffer_load_dwordx2 v[124:125], v23, s[4:7], s9 offen offset:2560 sc1
    s_waitcnt lgkmcnt(8)
    v_smfmac_f32_16x16x64_bf16 v[160:163], v[244:247], v[88:95], v4
    ds_read_b64_tr_b16 v[216:217], v18 offset:12288
    s_waitcnt vmcnt(11)
    v_smfmac_f32_16x16x64_bf16 v[164:167], v[244:247], v[88:95], v4 abid:1
    ds_read_b64_tr_b16 v[218:219], v18 offset:13824
    ds_write_b32 v20, v20 offset:64
    v_smfmac_f32_16x16x64_bf16 v[168:171], v[248:251], v[88:95], v4
    ds_read_b64_tr_b16 v[220:221], v18 offset:12320
    v_max3_f32 v21, |v97|, |v99|, 0
    v_smfmac_f32_16x16x64_bf16 v[172:175], v[248:251], v[88:95], v4 abid:1
    buffer_load_dwordx2 v[126:127], v23, s[4:7], s9 offen offset:2688 sc1
    v_smfmac_f32_16x16x64_bf16 v[176:179], v[252:255], v[88:95], v4
    ds_read_b64_tr_b16 v[222:223], v18 offset:13856
    ds_read_b64_tr_b16 v[224:225], v18 offset:12352
    v_smfmac_f32_16x16x64_bf16 v[180:183], v[252:255], v[88:95], v4 abid:1
    ds_read_b64_tr_b16 v[226:227], v18 offset:13888
    v_max3_f32 v21, |v101|, |v103|, v21
    s_waitcnt lgkmcnt(7)
    v_smfmac_f32_16x16x64_bf16 v[128:131], v[200:203], v[96:103], v4
    buffer_load_dwordx2 v[64:65], v22, s[4:7], s10 offen offset:0 sc1
    v_smfmac_f32_16x16x64_bf16 v[132:135], v[200:203], v[96:103], v4 abid:1
    ds_read_b64_tr_b16 v[228:229], v28 offset:20480
    ds_read_b64_tr_b16 v[230:231], v28 offset:22528
    v_smfmac_f32_16x16x64_bf16 v[136:139], v[204:207], v[96:103], v4
    ds_read_b64_tr_b16 v[232:233], v29 offset:20480
    ds_read_b64_tr_b16 v[234:235], v29 offset:22528
    v_smfmac_f32_16x16x64_bf16 v[140:143], v[204:207], v[96:103], v4 abid:1
    ds_read_b64_tr_b16 v[236:237], v30 offset:20480
    ds_read_b64_tr_b16 v[238:239], v30 offset:22528
    v_smfmac_f32_16x16x64_bf16 v[144:147], v[208:211], v[96:103], v4
    buffer_load_dwordx2 v[66:67], v22, s[4:7], s10 offen offset:128 sc1
    v_smfmac_f32_16x16x64_bf16 v[148:151], v[208:211], v[96:103], v4 abid:1
    ds_read_b64_tr_b16 v[240:241], v31 offset:20480
    v_smfmac_f32_16x16x64_bf16 v[152:155], v[212:215], v[96:103], v4
    ds_read_b64_tr_b16 v[242:243], v31 offset:22528
    v_smfmac_f32_16x16x64_bf16 v[156:159], v[212:215], v[96:103], v4 abid:1
    buffer_load_dwordx2 v[68:69], v22, s[4:7], s10 offen offset:512 sc1
    s_waitcnt lgkmcnt(8)
    v_smfmac_f32_16x16x64_bf16 v[160:163], v[216:219], v[96:103], v4
    ds_read_b64_tr_b16 v[244:245], v18 offset:15360
    s_waitcnt vmcnt(11)
    v_smfmac_f32_16x16x64_bf16 v[164:167], v[216:219], v[96:103], v4 abid:1
    ds_read_b64_tr_b16 v[246:247], v18 offset:16896
    v_smfmac_f32_16x16x64_bf16 v[168:171], v[220:223], v[96:103], v4
    ds_read_b64_tr_b16 v[248:249], v18 offset:15392
    v_max3_f32 v21, |v105|, |v107|, v21
    v_smfmac_f32_16x16x64_bf16 v[172:175], v[220:223], v[96:103], v4 abid:1
    buffer_load_dwordx2 v[70:71], v22, s[4:7], s10 offen offset:640 sc1
    v_smfmac_f32_16x16x64_bf16 v[176:179], v[224:227], v[96:103], v4
    ds_read_b64_tr_b16 v[250:251], v18 offset:16928
    ds_read_b64_tr_b16 v[252:253], v18 offset:15424
    v_smfmac_f32_16x16x64_bf16 v[180:183], v[224:227], v[96:103], v4 abid:1
    ds_read_b64_tr_b16 v[254:255], v18 offset:16960
    v_max3_f32 v21, |v109|, |v111|, v21
    s_waitcnt lgkmcnt(6)
    v_smfmac_f32_16x16x64_bf16 v[128:131], v[228:231], v[104:111], v4
    buffer_load_dwordx2 v[72:73], v22, s[4:7], s10 offen offset:2048 sc1
    v_smfmac_f32_16x16x64_bf16 v[132:135], v[228:231], v[104:111], v4 abid:1
    ds_read_b64_tr_b16 v[200:201], v28 offset:24576
    ds_read_b64_tr_b16 v[202:203], v28 offset:26624
    v_smfmac_f32_16x16x64_bf16 v[136:139], v[232:235], v[104:111], v4
    ds_read_b64_tr_b16 v[204:205], v29 offset:24576
    ds_read_b64_tr_b16 v[206:207], v29 offset:26624
    v_smfmac_f32_16x16x64_bf16 v[140:143], v[232:235], v[104:111], v4 abid:1
    ds_read_b64_tr_b16 v[208:209], v30 offset:24576
    ds_read_b64_tr_b16 v[210:211], v30 offset:26624
    v_smfmac_f32_16x16x64_bf16 v[144:147], v[236:239], v[104:111], v4
    buffer_load_dwordx2 v[74:75], v22, s[4:7], s10 offen offset:2176 sc1
    v_smfmac_f32_16x16x64_bf16 v[148:151], v[236:239], v[104:111], v4 abid:1
    ds_read_b64_tr_b16 v[212:213], v31 offset:24576
    v_smfmac_f32_16x16x64_bf16 v[152:155], v[240:243], v[104:111], v4
    ds_read_b64_tr_b16 v[214:215], v31 offset:26624
    v_smfmac_f32_16x16x64_bf16 v[156:159], v[240:243], v[104:111], v4 abid:1
    buffer_load_dwordx2 v[76:77], v22, s[4:7], s10 offen offset:2560 sc1
    s_waitcnt lgkmcnt(8)
    v_smfmac_f32_16x16x64_bf16 v[160:163], v[244:247], v[104:111], v4
    ds_read_b64_tr_b16 v[216:217], v18 offset:18432
    s_waitcnt vmcnt(11)
    v_smfmac_f32_16x16x64_bf16 v[164:167], v[244:247], v[104:111], v4 abid:1
    ds_read_b64_tr_b16 v[218:219], v18 offset:19968
    v_smfmac_f32_16x16x64_bf16 v[168:171], v[248:251], v[104:111], v4
    ds_read_b64_tr_b16 v[220:221], v18 offset:18464
    v_max3_f32 v21, |v113|, |v115|, v21
    v_smfmac_f32_16x16x64_bf16 v[172:175], v[248:251], v[104:111], v4 abid:1
    buffer_load_dwordx2 v[78:79], v22, s[4:7], s10 offen offset:2688 sc1
    v_smfmac_f32_16x16x64_bf16 v[176:179], v[252:255], v[104:111], v4
    ds_read_b64_tr_b16 v[222:223], v18 offset:20000
    ds_read_b64_tr_b16 v[224:225], v18 offset:18496
    v_smfmac_f32_16x16x64_bf16 v[180:183], v[252:255], v[104:111], v4 abid:1
    ds_read_b64_tr_b16 v[226:227], v18 offset:20032
    v_max3_f32 v21, |v117|, |v119|, v21
    s_waitcnt lgkmcnt(6)
    v_smfmac_f32_16x16x64_bf16 v[128:131], v[200:203], v[112:119], v4
    buffer_load_dwordx2 v[80:81], v23, s[4:7], s10 offen offset:0 sc1
    v_smfmac_f32_16x16x64_bf16 v[132:135], v[200:203], v[112:119], v4 abid:1
    ds_read_b64_tr_b16 v[228:229], v28 offset:28672
    ds_read_b64_tr_b16 v[230:231], v28 offset:30720
    v_smfmac_f32_16x16x64_bf16 v[136:139], v[204:207], v[112:119], v4
    ds_read_b64_tr_b16 v[232:233], v29 offset:28672
    ds_read_b64_tr_b16 v[234:235], v29 offset:30720
    v_smfmac_f32_16x16x64_bf16 v[140:143], v[204:207], v[112:119], v4 abid:1
    ds_read_b64_tr_b16 v[236:237], v30 offset:28672
    ds_read_b64_tr_b16 v[238:239], v30 offset:30720
    v_smfmac_f32_16x16x64_bf16 v[144:147], v[208:211], v[112:119], v4
    buffer_load_dwordx2 v[82:83], v23, s[4:7], s10 offen offset:128 sc1
    v_smfmac_f32_16x16x64_bf16 v[148:151], v[208:211], v[112:119], v4 abid:1
    ds_read_b64_tr_b16 v[240:241], v31 offset:28672
    v_smfmac_f32_16x16x64_bf16 v[152:155], v[212:215], v[112:119], v4
    ds_read_b64_tr_b16 v[242:243], v31 offset:30720
    v_smfmac_f32_16x16x64_bf16 v[156:159], v[212:215], v[112:119], v4 abid:1
    buffer_load_dwordx2 v[84:85], v23, s[4:7], s10 offen offset:512 sc1
    s_waitcnt lgkmcnt(8)
    v_smfmac_f32_16x16x64_bf16 v[160:163], v[216:219], v[112:119], v4
    ds_read_b64_tr_b16 v[244:245], v18 offset:21504
    s_waitcnt vmcnt(11)
    v_smfmac_f32_16x16x64_bf16 v[164:167], v[216:219], v[112:119], v4 abid:1
    ds_read_b64_tr_b16 v[246:247], v18 offset:23040
    v_smfmac_f32_16x16x64_bf16 v[168:171], v[220:223], v[112:119], v4
    ds_read_b64_tr_b16 v[248:249], v18 offset:21536
    v_max3_f32 v21, |v121|, |v123|, v21
    v_smfmac_f32_16x16x64_bf16 v[172:175], v[220:223], v[112:119], v4 abid:1
    buffer_load_dwordx2 v[86:87], v23, s[4:7], s10 offen offset:640 sc1
    v_smfmac_f32_16x16x64_bf16 v[176:179], v[224:227], v[112:119], v4
    ds_read_b64_tr_b16 v[250:251], v18 offset:23072
    ds_read_b64_tr_b16 v[252:253], v18 offset:21568
    v_smfmac_f32_16x16x64_bf16 v[180:183], v[224:227], v[112:119], v4 abid:1
    ds_read_b64_tr_b16 v[254:255], v18 offset:23104
    v_max3_f32 v21, |v125|, |v127|, v21
    s_waitcnt lgkmcnt(6)
    v_smfmac_f32_16x16x64_bf16 v[128:131], v[228:231], v[120:127], v4
    buffer_load_dwordx2 v[88:89], v23, s[4:7], s10 offen offset:2048 sc1
    v_smfmac_f32_16x16x64_bf16 v[132:135], v[228:231], v[120:127], v4 abid:1
    ds_read_b64_tr_b16 v[200:201], v28 offset:32768
    ds_read_b64_tr_b16 v[202:203], v28 offset:34816
    v_smfmac_f32_16x16x64_bf16 v[136:139], v[232:235], v[120:127], v4
    ds_read_b64_tr_b16 v[204:205], v29 offset:32768
    ds_read_b64_tr_b16 v[206:207], v29 offset:34816
    v_smfmac_f32_16x16x64_bf16 v[140:143], v[232:235], v[120:127], v4 abid:1
    ds_read_b64_tr_b16 v[208:209], v30 offset:32768
    ds_read_b64_tr_b16 v[210:211], v30 offset:34816
    v_smfmac_f32_16x16x64_bf16 v[144:147], v[236:239], v[120:127], v4
    buffer_load_dwordx2 v[90:91], v23, s[4:7], s10 offen offset:2176 sc1
    v_smfmac_f32_16x16x64_bf16 v[148:151], v[236:239], v[120:127], v4 abid:1
    ds_read_b64_tr_b16 v[212:213], v31 offset:32768
    v_smfmac_f32_16x16x64_bf16 v[152:155], v[240:243], v[120:127], v4
    ds_read_b64_tr_b16 v[214:215], v31 offset:34816
    v_smfmac_f32_16x16x64_bf16 v[156:159], v[240:243], v[120:127], v4 abid:1
    buffer_load_dwordx2 v[92:93], v23, s[4:7], s10 offen offset:2560 sc1
    s_waitcnt lgkmcnt(8)
    v_smfmac_f32_16x16x64_bf16 v[160:163], v[244:247], v[120:127], v4
    ds_read_b64_tr_b16 v[216:217], v18 offset:24576
    s_waitcnt vmcnt(11)
    v_smfmac_f32_16x16x64_bf16 v[164:167], v[244:247], v[120:127], v4 abid:1
    ds_read_b64_tr_b16 v[218:219], v18 offset:26112
    v_smfmac_f32_16x16x64_bf16 v[168:171], v[248:251], v[120:127], v4
    ds_read_b64_tr_b16 v[220:221], v18 offset:24608
    v_max3_f32 v21, |v65|, |v67|, v21
    v_smfmac_f32_16x16x64_bf16 v[172:175], v[248:251], v[120:127], v4 abid:1
    buffer_load_dwordx2 v[94:95], v23, s[4:7], s10 offen offset:2688 sc1
    v_smfmac_f32_16x16x64_bf16 v[176:179], v[252:255], v[120:127], v4
    ds_read_b64_tr_b16 v[222:223], v18 offset:26144
    ds_read_b64_tr_b16 v[224:225], v18 offset:24640
    v_smfmac_f32_16x16x64_bf16 v[180:183], v[252:255], v[120:127], v4 abid:1
    ds_read_b64_tr_b16 v[226:227], v18 offset:26176
    v_max3_f32 v21, |v69|, |v71|, v21
    s_waitcnt lgkmcnt(6)
    v_smfmac_f32_16x16x64_bf16 v[128:131], v[200:203], v[64:71], v4
    buffer_load_dwordx2 v[96:97], v22, s[4:7], s11 offen offset:0 sc1
    v_smfmac_f32_16x16x64_bf16 v[132:135], v[200:203], v[64:71], v4 abid:1
    ds_read_b64_tr_b16 v[228:229], v28 offset:36864
    ds_read_b64_tr_b16 v[230:231], v28 offset:38912
    v_smfmac_f32_16x16x64_bf16 v[136:139], v[204:207], v[64:71], v4
    ds_read_b64_tr_b16 v[232:233], v29 offset:36864
    ds_read_b64_tr_b16 v[234:235], v29 offset:38912
    v_smfmac_f32_16x16x64_bf16 v[140:143], v[204:207], v[64:71], v4 abid:1
    ds_read_b64_tr_b16 v[236:237], v30 offset:36864
    ds_read_b64_tr_b16 v[238:239], v30 offset:38912
    v_smfmac_f32_16x16x64_bf16 v[144:147], v[208:211], v[64:71], v4
    buffer_load_dwordx2 v[98:99], v22, s[4:7], s11 offen offset:128 sc1
    v_smfmac_f32_16x16x64_bf16 v[148:151], v[208:211], v[64:71], v4 abid:1
    ds_read_b64_tr_b16 v[240:241], v31 offset:36864
    v_smfmac_f32_16x16x64_bf16 v[152:155], v[212:215], v[64:71], v4
    ds_read_b64_tr_b16 v[242:243], v31 offset:38912
    v_smfmac_f32_16x16x64_bf16 v[156:159], v[212:215], v[64:71], v4 abid:1
    buffer_load_dwordx2 v[100:101], v22, s[4:7], s11 offen offset:512 sc1
    s_waitcnt lgkmcnt(8)
    v_smfmac_f32_16x16x64_bf16 v[160:163], v[216:219], v[64:71], v4
    ds_read_b64_tr_b16 v[244:245], v18 offset:27648
    s_waitcnt vmcnt(11)
    v_smfmac_f32_16x16x64_bf16 v[164:167], v[216:219], v[64:71], v4 abid:1
    ds_read_b64_tr_b16 v[246:247], v18 offset:29184
    v_smfmac_f32_16x16x64_bf16 v[168:171], v[220:223], v[64:71], v4
    ds_read_b64_tr_b16 v[248:249], v18 offset:27680
    v_max3_f32 v21, |v73|, |v75|, v21
    v_smfmac_f32_16x16x64_bf16 v[172:175], v[220:223], v[64:71], v4 abid:1
    buffer_load_dwordx2 v[102:103], v22, s[4:7], s11 offen offset:640 sc1
    v_smfmac_f32_16x16x64_bf16 v[176:179], v[224:227], v[64:71], v4
    ds_read_b64_tr_b16 v[250:251], v18 offset:29216
    ds_read_b64_tr_b16 v[252:253], v18 offset:27712
    v_smfmac_f32_16x16x64_bf16 v[180:183], v[224:227], v[64:71], v4 abid:1
    ds_read_b64_tr_b16 v[254:255], v18 offset:29248
    v_max3_f32 v21, |v77|, |v79|, v21
    s_waitcnt lgkmcnt(6)
    v_smfmac_f32_16x16x64_bf16 v[128:131], v[228:231], v[72:79], v4
    buffer_load_dwordx2 v[104:105], v22, s[4:7], s11 offen offset:2048 sc1
    v_smfmac_f32_16x16x64_bf16 v[132:135], v[228:231], v[72:79], v4 abid:1
    ds_read_b64_tr_b16 v[200:201], v28 offset:40960
    ds_read_b64_tr_b16 v[202:203], v28 offset:43008
    v_smfmac_f32_16x16x64_bf16 v[136:139], v[232:235], v[72:79], v4
    ds_read_b64_tr_b16 v[204:205], v29 offset:40960
    ds_read_b64_tr_b16 v[206:207], v29 offset:43008
    v_smfmac_f32_16x16x64_bf16 v[140:143], v[232:235], v[72:79], v4 abid:1
    ds_read_b64_tr_b16 v[208:209], v30 offset:40960
    ds_read_b64_tr_b16 v[210:211], v30 offset:43008
    v_smfmac_f32_16x16x64_bf16 v[144:147], v[236:239], v[72:79], v4
    buffer_load_dwordx2 v[106:107], v22, s[4:7], s11 offen offset:2176 sc1
    v_smfmac_f32_16x16x64_bf16 v[148:151], v[236:239], v[72:79], v4 abid:1
    ds_read_b64_tr_b16 v[212:213], v31 offset:40960
    v_smfmac_f32_16x16x64_bf16 v[152:155], v[240:243], v[72:79], v4
    ds_read_b64_tr_b16 v[214:215], v31 offset:43008
    v_smfmac_f32_16x16x64_bf16 v[156:159], v[240:243], v[72:79], v4 abid:1
    buffer_load_dwordx2 v[108:109], v22, s[4:7], s11 offen offset:2560 sc1
    s_waitcnt lgkmcnt(8)
    v_smfmac_f32_16x16x64_bf16 v[160:163], v[244:247], v[72:79], v4
    ds_read_b64_tr_b16 v[216:217], v18 offset:30720
    s_waitcnt vmcnt(11)
    v_smfmac_f32_16x16x64_bf16 v[164:167], v[244:247], v[72:79], v4 abid:1
    ds_read_b64_tr_b16 v[218:219], v18 offset:32256
    v_smfmac_f32_16x16x64_bf16 v[168:171], v[248:251], v[72:79], v4
    ds_read_b64_tr_b16 v[220:221], v18 offset:30752
    v_max3_f32 v21, |v81|, |v83|, v21
    v_smfmac_f32_16x16x64_bf16 v[172:175], v[248:251], v[72:79], v4 abid:1
    buffer_load_dwordx2 v[110:111], v22, s[4:7], s11 offen offset:2688 sc1
    v_smfmac_f32_16x16x64_bf16 v[176:179], v[252:255], v[72:79], v4
    ds_read_b64_tr_b16 v[222:223], v18 offset:32288
    ds_read_b64_tr_b16 v[224:225], v18 offset:30784
    v_smfmac_f32_16x16x64_bf16 v[180:183], v[252:255], v[72:79], v4 abid:1
    ds_read_b64_tr_b16 v[226:227], v18 offset:32320
    v_max3_f32 v21, |v85|, |v87|, v21
    s_waitcnt lgkmcnt(6)
    v_smfmac_f32_16x16x64_bf16 v[128:131], v[200:203], v[80:87], v4
    buffer_load_dwordx2 v[112:113], v23, s[4:7], s11 offen offset:0 sc1
    v_smfmac_f32_16x16x64_bf16 v[132:135], v[200:203], v[80:87], v4 abid:1
    ds_read_b64_tr_b16 v[228:229], v28 offset:45056
    ds_read_b64_tr_b16 v[230:231], v28 offset:47104
    v_smfmac_f32_16x16x64_bf16 v[136:139], v[204:207], v[80:87], v4
    ds_read_b64_tr_b16 v[232:233], v29 offset:45056
    ds_read_b64_tr_b16 v[234:235], v29 offset:47104
    v_smfmac_f32_16x16x64_bf16 v[140:143], v[204:207], v[80:87], v4 abid:1
    ds_read_b64_tr_b16 v[236:237], v30 offset:45056
    ds_read_b64_tr_b16 v[238:239], v30 offset:47104
    v_smfmac_f32_16x16x64_bf16 v[144:147], v[208:211], v[80:87], v4
    buffer_load_dwordx2 v[114:115], v23, s[4:7], s11 offen offset:128 sc1
    v_smfmac_f32_16x16x64_bf16 v[148:151], v[208:211], v[80:87], v4 abid:1
    ds_read_b64_tr_b16 v[240:241], v31 offset:45056
    v_smfmac_f32_16x16x64_bf16 v[152:155], v[212:215], v[80:87], v4
    ds_read_b64_tr_b16 v[242:243], v31 offset:47104
    v_smfmac_f32_16x16x64_bf16 v[156:159], v[212:215], v[80:87], v4 abid:1
    buffer_load_dwordx2 v[116:117], v23, s[4:7], s11 offen offset:512 sc1
    s_waitcnt lgkmcnt(8)
    v_smfmac_f32_16x16x64_bf16 v[160:163], v[216:219], v[80:87], v4
    ds_read_b64_tr_b16 v[244:245], v18 offset:33792
    s_waitcnt vmcnt(11)
    v_smfmac_f32_16x16x64_bf16 v[164:167], v[216:219], v[80:87], v4 abid:1
    ds_read_b64_tr_b16 v[246:247], v18 offset:35328
    v_smfmac_f32_16x16x64_bf16 v[168:171], v[220:223], v[80:87], v4
    ds_read_b64_tr_b16 v[248:249], v18 offset:33824
    v_max3_f32 v21, |v89|, |v91|, v21
    v_smfmac_f32_16x16x64_bf16 v[172:175], v[220:223], v[80:87], v4 abid:1
    buffer_load_dwordx2 v[118:119], v23, s[4:7], s11 offen offset:640 sc1
    v_smfmac_f32_16x16x64_bf16 v[176:179], v[224:227], v[80:87], v4
    ds_read_b64_tr_b16 v[250:251], v18 offset:35360
    ds_read_b64_tr_b16 v[252:253], v18 offset:33856
    v_smfmac_f32_16x16x64_bf16 v[180:183], v[224:227], v[80:87], v4 abid:1
    ds_read_b64_tr_b16 v[254:255], v18 offset:35392
    v_max3_f32 v21, |v93|, |v95|, v21
    s_waitcnt lgkmcnt(6)
    v_smfmac_f32_16x16x64_bf16 v[128:131], v[228:231], v[88:95], v4
    buffer_load_dwordx2 v[120:121], v23, s[4:7], s11 offen offset:2048 sc1
    v_smfmac_f32_16x16x64_bf16 v[132:135], v[228:231], v[88:95], v4 abid:1
    ds_read_b64_tr_b16 v[200:201], v28 offset:49152
    ds_read_b64_tr_b16 v[202:203], v28 offset:51200
    v_cmp_le_f32 vcc, s52, v21
    v_smfmac_f32_16x16x64_bf16 v[136:139], v[232:235], v[88:95], v4
    ds_read_b64_tr_b16 v[204:205], v29 offset:49152
    ds_read_b64_tr_b16 v[206:207], v29 offset:51200
    v_smfmac_f32_16x16x64_bf16 v[140:143], v[232:235], v[88:95], v4 abid:1
    ds_read_b64_tr_b16 v[208:209], v30 offset:49152
    ds_read_b64_tr_b16 v[210:211], v30 offset:51200
    s_cbranch_vccnz R_redo
B_redo:
    v_smfmac_f32_16x16x64_bf16 v[144:147], v[236:239], v[88:95], v4
    buffer_load_dwordx2 v[122:123], v23, s[4:7], s11 offen offset:2176 sc1
    v_smfmac_f32_16x16x64_bf16 v[148:151], v[236:239], v[88:95], v4 abid:1
    ds_read_b64_tr_b16 v[212:213], v31 offset:49152
    s_waitcnt vmcnt(10)
    v_smfmac_f32_16x16x64_bf16 v[152:155], v[240:243], v[88:95], v4
    ds_read_b64_tr_b16 v[214:215], v31 offset:51200
    v_max3_f32 v8, |v97|, |v99|, |v101|
    v_smfmac_f32_16x16x64_bf16 v[156:159], v[240:243], v[88:95], v4 abid:1
    s_branch S_1o
S_1:
    s_branch S_back
S_1o:
    buffer_load_dwordx2 v[124:125], v23, s[4:7], s11 offen offset:2560 sc1
    s_waitcnt lgkmcnt(8)
    v_smfmac_f32_16x16x64_bf16 v[160:163], v[244:247], v[88:95], v4
    ds_read_b64_tr_b16 v[216:217], v19 offset:0
    v_max_f32_e64 v8, |v103|, v8
    v_smfmac_f32_16x16x64_bf16 v[164:167], v[244:247], v[88:95], v4 abid:1
    ds_read_b64_tr_b16 v[218:219], v19 offset:1536
    v_smfmac_f32_16x16x64_bf16 v[168:171], v[248:251], v[88:95], v4
    ds_read_b64_tr_b16 v[220:221], v19 offset:32
    v_cmp_le_f32 vcc, s52, v8
    v_smfmac_f32_16x16x64_bf16 v[172:175], v[248:251], v[88:95], v4 abid:1
    buffer_load_dwordx2 v[126:127], v23, s[4:7], s11 offen offset:2688 sc1
    v_smfmac_f32_16x16x64_bf16 v[176:179], v[252:255], v[88:95], v4
    ds_read_b64_tr_b16 v[222:223], v19 offset:1568
    ds_read_b64_tr_b16 v[224:225], v19 offset:64
    v_smfmac_f32_16x16x64_bf16 v[180:183], v[252:255], v[88:95], v4 abid:1
    ds_read_b64_tr_b16 v[226:227], v19 offset:1600
    s_cbranch_vccnz R_h12
B_h12:
    s_waitcnt lgkmcnt(6)
    v_smfmac_f32_16x16x64_bf16 v[128:131], v[200:203], v[96:103], v4
    ds_read_b64_tr_b16 v[228:229], v28 offset:53248
    v_smfmac_f32_16x16x64_bf16 v[132:135], v[200:203], v[96:103], v4 abid:1
    ds_read_b64_tr_b16 v[230:231], v28 offset:55296
    ds_read_b64_tr_b16 v[232:233], v29 offset:53248
    v_smfmac_f32_16x16x64_bf16 v[136:139], v[204:207], v[96:103], v4
    ds_read_b64_tr_b16 v[234:235], v29 offset:55296
    ds_read_b64_tr_b16 v[236:237], v28 offset:57344
    v_smfmac_f32_16x16x64_bf16 v[140:143], v[204:207], v[96:103], v4 abid:1
    ds_read_b64_tr_b16 v[238:239], v28 offset:59392
    ds_read_b64_tr_b16 v[240:241], v29 offset:57344
    v_smfmac_f32_16x16x64_bf16 v[144:147], v[208:211], v[96:103], v4
    ds_read_b64_tr_b16 v[242:243], v29 offset:59392
    ds_write_b32 v20, v20 offset:32
    v_smfmac_f32_16x16x64_bf16 v[148:151], v[208:211], v[96:103], v4 abid:1
    ds_read_b64_tr_b16 v[244:245], v28 offset:61440
    s_waitcnt vmcnt(8)
    v_smfmac_f32_16x16x64_bf16 v[152:155], v[212:215], v[96:103], v4
    ds_read_b64_tr_b16 v[246:247], v28 offset:63488
    v_max3_f32 v8, |v105|, |v107|, |v109|
    v_smfmac_f32_16x16x64_bf16 v[156:159], v[212:215], v[96:103], v4 abid:1
    ds_read_b64_tr_b16 v[248:249], v29 offset:61440
    s_waitcnt lgkmcnt(12)
    v_smfmac_f32_16x16x64_bf16 v[160:163], v[216:219], v[96:103], v4
    ds_read_b64_tr_b16 v[250:251], v29 offset:63488
    v_max_f32_e64 v8, |v111|, v8
    v_smfmac_f32_16x16x64_bf16 v[164:167], v[216:219], v[96:103], v4 abid:1
    ds_read_b64_tr_b16 v[64:65], v30 offset:53248
    v_smfmac_f32_16x16x64_bf16 v[168:171], v[220:223], v[96:103], v4
    ds_read_b64_tr_b16 v[66:67], v30 offset:55296
    v_cmp_le_f32 vcc, s52, v8
    v_smfmac_f32_16x16x64_bf16 v[172:175], v[220:223], v[96:103], v4 abid:1
    ds_read_b64_tr_b16 v[68:69], v30 offset:57344
    v_smfmac_f32_16x16x64_bf16 v[176:179], v[224:227], v[96:103], v4
    ds_read_b64_tr_b16 v[70:71], v30 offset:59392
    ds_read_b64_tr_b16 v[72:73], v30 offset:61440
    v_smfmac_f32_16x16x64_bf16 v[180:183], v[224:227], v[96:103], v4 abid:1
    ds_read_b64_tr_b16 v[74:75], v30 offset:63488
    s_cbranch_vccnz R_h13
B_h13:
    s_waitcnt lgkmcnt(15)
    v_smfmac_f32_16x16x64_bf16 v[128:131], v[228:231], v[104:111], v4
    s_waitcnt vmcnt(4)
    v_max3_f32 v8, |v113|, |v115|, |v117|
    v_smfmac_f32_16x16x64_bf16 v[132:135], v[228:231], v[104:111], v4 abid:1
    v_max_f32_e64 v8, |v119|, v8
    v_smfmac_f32_16x16x64_bf16 v[136:139], v[232:235], v[104:111], v4
    v_cmp_le_f32 vcc, s52, v8
    v_smfmac_f32_16x16x64_bf16 v[140:143], v[232:235], v[104:111], v4 abid:1
    s_cbranch_vccnz R_h14
B_h14:
    s_waitcnt lgkmcnt(11)
    v_smfmac_f32_16x16x64_bf16 v[128:131], v[236:239], v[112:119], v4
    ds_read_b32 v9, v20 offset:48
    s_waitcnt vmcnt(0)
    v_max3_f32 v8, |v121|, |v123|, |v125|
    v_smfmac_f32_16x16x64_bf16 v[132:135], v[236:239], v[112:119], v4 abid:1
    ds_read2_b64 v[10:13], v25 offset0:16 offset1:34
    v_max_f32_e64 v8, |v127|, v8
    v_smfmac_f32_16x16x64_bf16 v[136:139], v[240:243], v[112:119], v4
    ds_read_b128 v[184:187], v24
    v_cmp_le_f32 vcc, s52, v8
    v_smfmac_f32_16x16x64_bf16 v[140:143], v[240:243], v[112:119], v4 abid:1
    ds_read_b128 v[188:191], v24 offset:512
    s_cbranch_vccnz R_h15
B_h15:
    s_waitcnt lgkmcnt(10)
    v_smfmac_f32_16x16x64_bf16 v[128:131], v[244:247], v[120:127], v4
    s_waitcnt lgkmcnt(3)
    v_cmp_eq_u32 vcc, 0, v9
    v_smfmac_f32_16x16x64_bf16 v[132:135], v[244:247], v[120:127], v4 abid:1
    v_smfmac_f32_16x16x64_bf16 v[136:139], v[248:251], v[120:127], v4
    v_smfmac_f32_16x16x64_bf16 v[140:143], v[248:251], v[120:127], v4 abid:1
    s_cbranch_vccnz R_st
B_st:
    ds_read_b128 v[192:195], v24 offset:64
    ds_read_b128 v[196:199], v24 offset:576
    s_waitcnt lgkmcnt(2)
    .p2align 3
    v_pk_fma_f32 v[232:233], v[184:185], v[10:11], v[188:189] op_sel:[0,1,0] op_sel_hi:[1,1,1] neg_lo:[1,0,0] neg_hi:[1,0,0]
    v_pk_fma_f32 v[234:235], v[186:187], v[10:11], v[190:191] op_sel:[0,1,0] op_sel_hi:[1,1,1] neg_lo:[1,0,0] neg_hi:[1,0,0]
    v_pk_fma_f32 v[236:237], v[184:185], v[12:13], v[188:189] op_sel:[0,1,0] op_sel_hi:[1,1,1] neg_lo:[1,0,0] neg_hi:[1,0,0]
    v_pk_fma_f32 v[238:239], v[186:187], v[12:13], v[190:191] op_sel:[0,1,0] op_sel_hi:[1,1,1] neg_lo:[1,0,0] neg_hi:[1,0,0]
    v_pk_fma_f32 v[128:129], v[128:129], v[10:11], v[232:233] op_sel_hi:[1,0,1]
    v_pk_fma_f32 v[130:131], v[130:131], v[10:11], v[234:235] op_sel_hi:[1,0,1]
    v_pk_fma_f32 v[132:133], v[132:133], v[12:13], v[236:237] op_sel_hi:[1,0,1]
    v_pk_fma_f32 v[134:135], v[134:135], v[12:13], v[238:239] op_sel_hi:[1,0,1]
    v_pk_mul_f32 v[232:233], v[128:129], v[128:129]
    v_pk_mul_f32 v[234:235], v[130:131], v[130:131]
    v_pk_mul_f32 v[236:237], v[132:133], v[132:133]
    v_pk_mul_f32 v[238:239], v[134:135], v[134:135]
    v_pk_fma_f32 v[232:233], v[232:233], v[14:15], v[14:15] op_sel:[0,0,1] op_sel_hi:[1,0,1]
    v_pk_fma_f32 v[234:235], v[234:235], v[14:15], v[14:15] op_sel:[0,0,1] op_sel_hi:[1,0,1]
    v_pk_fma_f32 v[236:237], v[236:237], v[14:15], v[14:15] op_sel:[0,0,1] op_sel_hi:[1,0,1]
    v_pk_fma_f32 v[238:239], v[238:239], v[14:15], v[14:15] op_sel:[0,0,1] op_sel_hi:[1,0,1]
    v_pk_fma_f32 v[232:233], v[232:233], v[128:129], v[16:17] op_sel:[0,0,1] op_sel_hi:[1,1,1]
    v_pk_fma_f32 v[234:235], v[234:235], v[130:131], v[16:17] op_sel:[0,0,1] op_sel_hi:[1,1,1]
    v_pk_fma_f32 v[236:237], v[236:237], v[132:133], v[16:17] op_sel:[0,0,1] op_sel_hi:[1,1,1]
    v_pk_fma_f32 v[238:239], v[238:239], v[134:135], v[16:17] op_sel:[0,0,1] op_sel_hi:[1,1,1]
    v_smfmac_f32_16x16x64_bf16 v[144:147], v[64:67], v[104:111], v4
    ds_read_b64_tr_b16 v[80:81], v31 offset:53248
    v_exp_f32_e64 v232, v232 clamp
    v_smfmac_f32_16x16x64_bf16 v[148:151], v[64:67], v[104:111], v4 abid:1
    ds_read_b64_tr_b16 v[82:83], v31 offset:55296
    v_exp_f32_e64 v233, v233 clamp
    v_smfmac_f32_16x16x64_bf16 v[144:147], v[68:71], v[112:119], v4
    ds_read_b64_tr_b16 v[84:85], v31 offset:57344
    v_exp_f32_e64 v234, v234 clamp
    v_smfmac_f32_16x16x64_bf16 v[148:151], v[68:71], v[112:119], v4 abid:1
    ds_read_b64_tr_b16 v[86:87], v31 offset:59392
    v_exp_f32_e64 v235, v235 clamp
    v_smfmac_f32_16x16x64_bf16 v[144:147], v[72:75], v[120:127], v4
    ds_read_b64_tr_b16 v[88:89], v31 offset:61440
    v_exp_f32_e64 v236, v236 clamp
    v_smfmac_f32_16x16x64_bf16 v[148:151], v[72:75], v[120:127], v4 abid:1
    ds_read_b64_tr_b16 v[90:91], v31 offset:63488
    v_exp_f32_e64 v237, v237 clamp
    v_exp_f32_e64 v238, v238 clamp
    v_exp_f32_e64 v239, v239 clamp
    .p2align 3
    v_pk_add_f32 v[232:233], v[232:233], v[16:17] op_sel_hi:[1,0]
    v_pk_add_f32 v[234:235], v[234:235], v[16:17] op_sel_hi:[1,0]
    v_pk_add_f32 v[236:237], v[236:237], v[16:17] op_sel_hi:[1,0]
    v_pk_add_f32 v[238:239], v[238:239], v[16:17] op_sel_hi:[1,0]
    v_pk_mul_f32 v[248:249], v[232:233], v[234:235]
    v_pk_mul_f32 v[250:251], v[236:237], v[238:239]
    v_pk_mul_f32 v[128:129], v[128:129], v[234:235]
    v_pk_mul_f32 v[252:253], v[248:249], v[250:251]
    v_pk_mul_f32 v[130:131], v[130:131], v[232:233]
    v_rcp_f32 v252, v252
    v_rcp_f32_e64 v253, v253
    s_waitcnt lgkmcnt(6)
    .p2align 3
    v_pk_mul_f32 v[132:133], v[132:133], v[238:239]
    v_pk_mul_f32 v[250:251], v[250:251], v[252:253]
    v_pk_mul_f32 v[248:249], v[248:249], v[252:253]
    v_pk_mul_f32 v[134:135], v[134:135], v[236:237]
    v_pk_mul_f32 v[232:233], v[128:129], v[250:251]
    v_pk_mul_f32 v[234:235], v[130:131], v[250:251]
    v_pk_mul_f32 v[236:237], v[132:133], v[248:249]
    v_pk_mul_f32 v[238:239], v[134:135], v[248:249]
    v_cvt_pk_bf16_f32 v28, v232, v233
    v_cvt_pk_bf16_f32 v30, v236, v237
    v_cvt_pk_bf16_f32 v29, v234, v235
    v_cvt_pk_bf16_f32 v31, v238, v239
    v_permlane16_swap_b32 v28, v30
    v_bfi_b32 v240, s48, v0, v28
    v_permlane16_swap_b32 v29, v31
    v_bfi_b32 v242, s48, v0, v30
    v_bfi_b32 v241, s48, v7, v29
    v_bfi_b32 v243, s48, v7, v31
    .p2align 3
    v_pk_fma_f32 v[232:233], v[192:193], v[10:11], v[196:197] op_sel:[0,1,0] op_sel_hi:[1,1,1] neg_lo:[1,0,0] neg_hi:[1,0,0]
    v_pk_fma_f32 v[234:235], v[194:195], v[10:11], v[198:199] op_sel:[0,1,0] op_sel_hi:[1,1,1] neg_lo:[1,0,0] neg_hi:[1,0,0]
    v_pk_fma_f32 v[236:237], v[192:193], v[12:13], v[196:197] op_sel:[0,1,0] op_sel_hi:[1,1,1] neg_lo:[1,0,0] neg_hi:[1,0,0]
    v_pk_fma_f32 v[238:239], v[194:195], v[12:13], v[198:199] op_sel:[0,1,0] op_sel_hi:[1,1,1] neg_lo:[1,0,0] neg_hi:[1,0,0]
    buffer_store_dwordx4 v[240:243], v3, s[4:7], s31 offen offset:0 sc1
    ds_read_b128 v[184:187], v24 offset:128
    ds_read_b128 v[188:191], v24 offset:640
    v_pk_fma_f32 v[136:137], v[136:137], v[10:11], v[232:233] op_sel_hi:[1,0,1]
    v_pk_fma_f32 v[138:139], v[138:139], v[10:11], v[234:235] op_sel_hi:[1,0,1]
    v_pk_fma_f32 v[140:141], v[140:141], v[12:13], v[236:237] op_sel_hi:[1,0,1]
    v_pk_fma_f32 v[142:143], v[142:143], v[12:13], v[238:239] op_sel_hi:[1,0,1]
    v_pk_mul_f32 v[232:233], v[136:137], v[136:137]
    v_pk_mul_f32 v[234:235], v[138:139], v[138:139]
    v_pk_mul_f32 v[236:237], v[140:141], v[140:141]
    v_pk_mul_f32 v[238:239], v[142:143], v[142:143]
    v_pk_fma_f32 v[232:233], v[232:233], v[14:15], v[14:15] op_sel:[0,0,1] op_sel_hi:[1,0,1]
    v_pk_fma_f32 v[234:235], v[234:235], v[14:15], v[14:15] op_sel:[0,0,1] op_sel_hi:[1,0,1]
    v_pk_fma_f32 v[236:237], v[236:237], v[14:15], v[14:15] op_sel:[0,0,1] op_sel_hi:[1,0,1]
    v_pk_fma_f32 v[238:239], v[238:239], v[14:15], v[14:15] op_sel:[0,0,1] op_sel_hi:[1,0,1]
    v_pk_fma_f32 v[232:233], v[232:233], v[136:137], v[16:17] op_sel:[0,0,1] op_sel_hi:[1,1,1]
    v_pk_fma_f32 v[234:235], v[234:235], v[138:139], v[16:17] op_sel:[0,0,1] op_sel_hi:[1,1,1]
    v_pk_fma_f32 v[236:237], v[236:237], v[140:141], v[16:17] op_sel:[0,0,1] op_sel_hi:[1,1,1]
    v_pk_fma_f32 v[238:239], v[238:239], v[142:143], v[16:17] op_sel:[0,0,1] op_sel_hi:[1,1,1]
    s_waitcnt lgkmcnt(2)
    v_smfmac_f32_16x16x64_bf16 v[152:155], v[80:83], v[104:111], v4
    ds_read_b64_tr_b16 v[64:65], v19 offset:3072
    v_exp_f32_e64 v232, v232 clamp
    v_smfmac_f32_16x16x64_bf16 v[156:159], v[80:83], v[104:111], v4 abid:1
    ds_read_b64_tr_b16 v[66:67], v19 offset:4608
    v_exp_f32_e64 v233, v233 clamp
    v_smfmac_f32_16x16x64_bf16 v[152:155], v[84:87], v[112:119], v4
    ds_read_b64_tr_b16 v[68:69], v19 offset:6144
    v_exp_f32_e64 v234, v234 clamp
    v_smfmac_f32_16x16x64_bf16 v[156:159], v[84:87], v[112:119], v4 abid:1
    ds_read_b64_tr_b16 v[70:71], v19 offset:7680
    v_exp_f32_e64 v235, v235 clamp
    v_smfmac_f32_16x16x64_bf16 v[152:155], v[88:91], v[120:127], v4
    ds_read_b64_tr_b16 v[72:73], v19 offset:9216
    v_exp_f32_e64 v236, v236 clamp
    v_smfmac_f32_16x16x64_bf16 v[156:159], v[88:91], v[120:127], v4 abid:1
    ds_read_b64_tr_b16 v[74:75], v19 offset:10752
    v_exp_f32_e64 v237, v237 clamp
    v_exp_f32_e64 v238, v238 clamp
    v_exp_f32_e64 v239, v239 clamp
    .p2align 3
    v_pk_add_f32 v[232:233], v[232:233], v[16:17] op_sel_hi:[1,0]
    v_pk_add_f32 v[234:235], v[234:235], v[16:17] op_sel_hi:[1,0]
    v_pk_add_f32 v[236:237], v[236:237], v[16:17] op_sel_hi:[1,0]
    v_pk_add_f32 v[238:239], v[238:239], v[16:17] op_sel_hi:[1,0]
    v_pk_mul_f32 v[248:249], v[232:233], v[234:235]
    v_pk_mul_f32 v[250:251], v[236:237], v[238:239]
    v_pk_mul_f32 v[136:137], v[136:137], v[234:235]
    v_pk_mul_f32 v[252:253], v[248:249], v[250:251]
    v_pk_mul_f32 v[138:139], v[138:139], v[232:233]
    v_rcp_f32 v252, v252
    v_rcp_f32_e64 v253, v253
    s_waitcnt lgkmcnt(6)
    .p2align 3
    v_pk_mul_f32 v[140:141], v[140:141], v[238:239]
    v_pk_mul_f32 v[250:251], v[250:251], v[252:253]
    v_pk_mul_f32 v[248:249], v[248:249], v[252:253]
    v_pk_mul_f32 v[142:143], v[142:143], v[236:237]
    v_pk_mul_f32 v[232:233], v[136:137], v[250:251]
    v_pk_mul_f32 v[234:235], v[138:139], v[250:251]
    v_pk_mul_f32 v[236:237], v[140:141], v[248:249]
    v_pk_mul_f32 v[238:239], v[142:143], v[248:249]
    v_cvt_pk_bf16_f32 v32, v232, v233
    v_cvt_pk_bf16_f32 v34, v236, v237
    v_cvt_pk_bf16_f32 v33, v234, v235
    v_cvt_pk_bf16_f32 v35, v238, v239
    v_permlane16_swap_b32 v32, v34
    v_bfi_b32 v244, s48, v0, v32
    v_permlane16_swap_b32 v33, v35
    v_bfi_b32 v246, s48, v0, v34
    v_bfi_b32 v245, s48, v7, v33
    v_bfi_b32 v247, s48, v7, v35
    .p2align 3
    v_pk_fma_f32 v[232:233], v[184:185], v[10:11], v[188:189] op_sel:[0,1,0] op_sel_hi:[1,1,1] neg_lo:[1,0,0] neg_hi:[1,0,0]
    v_pk_fma_f32 v[234:235], v[186:187], v[10:11], v[190:191] op_sel:[0,1,0] op_sel_hi:[1,1,1] neg_lo:[1,0,0] neg_hi:[1,0,0]
    v_pk_fma_f32 v[236:237], v[184:185], v[12:13], v[188:189] op_sel:[0,1,0] op_sel_hi:[1,1,1] neg_lo:[1,0,0] neg_hi:[1,0,0]
    v_pk_fma_f32 v[238:239], v[186:187], v[12:13], v[190:191] op_sel:[0,1,0] op_sel_hi:[1,1,1] neg_lo:[1,0,0] neg_hi:[1,0,0]
    buffer_store_dwordx4 v[244:247], v3, s[4:7], s31 offen offset:1024 sc1
    ds_read_b128 v[192:195], v24 offset:192
    ds_read_b128 v[196:199], v24 offset:704
    v_pk_fma_f32 v[144:145], v[144:145], v[10:11], v[232:233] op_sel_hi:[1,0,1]
    v_pk_fma_f32 v[146:147], v[146:147], v[10:11], v[234:235] op_sel_hi:[1,0,1]
    v_pk_fma_f32 v[148:149], v[148:149], v[12:13], v[236:237] op_sel_hi:[1,0,1]
    v_pk_fma_f32 v[150:151], v[150:151], v[12:13], v[238:239] op_sel_hi:[1,0,1]
    v_pk_mul_f32 v[232:233], v[144:145], v[144:145]
    v_pk_mul_f32 v[234:235], v[146:147], v[146:147]
    v_pk_mul_f32 v[236:237], v[148:149], v[148:149]
    v_pk_mul_f32 v[238:239], v[150:151], v[150:151]
    v_pk_fma_f32 v[232:233], v[232:233], v[14:15], v[14:15] op_sel:[0,0,1] op_sel_hi:[1,0,1]
    v_pk_fma_f32 v[234:235], v[234:235], v[14:15], v[14:15] op_sel:[0,0,1] op_sel_hi:[1,0,1]
    v_pk_fma_f32 v[236:237], v[236:237], v[14:15], v[14:15] op_sel:[0,0,1] op_sel_hi:[1,0,1]
    v_pk_fma_f32 v[238:239], v[238:239], v[14:15], v[14:15] op_sel:[0,0,1] op_sel_hi:[1,0,1]
    v_pk_fma_f32 v[232:233], v[232:233], v[144:145], v[16:17] op_sel:[0,0,1] op_sel_hi:[1,1,1]
    v_pk_fma_f32 v[234:235], v[234:235], v[146:147], v[16:17] op_sel:[0,0,1] op_sel_hi:[1,1,1]
    v_pk_fma_f32 v[236:237], v[236:237], v[148:149], v[16:17] op_sel:[0,0,1] op_sel_hi:[1,1,1]
    v_pk_fma_f32 v[238:239], v[238:239], v[150:151], v[16:17] op_sel:[0,0,1] op_sel_hi:[1,1,1]
    s_waitcnt lgkmcnt(2)
    v_smfmac_f32_16x16x64_bf16 v[160:163], v[64:67], v[104:111], v4
    ds_read_b64_tr_b16 v[80:81], v19 offset:3104
    v_exp_f32_e64 v232, v232 clamp
    v_smfmac_f32_16x16x64_bf16 v[164:167], v[64:67], v[104:111], v4 abid:1
    ds_read_b64_tr_b16 v[82:83], v19 offset:4640
    v_exp_f32_e64 v233, v233 clamp
    v_smfmac_f32_16x16x64_bf16 v[160:163], v[68:71], v[112:119], v4
    ds_read_b64_tr_b16 v[84:85], v19 offset:6176
    v_exp_f32_e64 v234, v234 clamp
    v_smfmac_f32_16x16x64_bf16 v[164:167], v[68:71], v[112:119], v4 abid:1
    ds_read_b64_tr_b16 v[86:87], v19 offset:7712
    v_exp_f32_e64 v235, v235 clamp
    v_smfmac_f32_16x16x64_bf16 v[160:163], v[72:75], v[120:127], v4
    ds_read_b64_tr_b16 v[88:89], v19 offset:9248
    v_exp_f32_e64 v236, v236 clamp
    v_smfmac_f32_16x16x64_bf16 v[164:167], v[72:75], v[120:127], v4 abid:1
    ds_read_b64_tr_b16 v[90:91], v19 offset:10784
    v_exp_f32_e64 v237, v237 clamp
    v_exp_f32_e64 v238, v238 clamp
    v_exp_f32_e64 v239, v239 clamp
    .p2align 3
    v_pk_add_f32 v[232:233], v[232:233], v[16:17] op_sel_hi:[1,0]
    v_pk_add_f32 v[234:235], v[234:235], v[16:17] op_sel_hi:[1,0]
    v_pk_add_f32 v[236:237], v[236:237], v[16:17] op_sel_hi:[1,0]
    v_pk_add_f32 v[238:239], v[238:239], v[16:17] op_sel_hi:[1,0]
    v_pk_mul_f32 v[248:249], v[232:233], v[234:235]
    v_pk_mul_f32 v[250:251], v[236:237], v[238:239]
    v_pk_mul_f32 v[144:145], v[144:145], v[234:235]
    v_pk_mul_f32 v[252:253], v[248:249], v[250:251]
    v_pk_mul_f32 v[146:147], v[146:147], v[232:233]
    v_rcp_f32 v252, v252
    v_rcp_f32_e64 v253, v253
    s_waitcnt lgkmcnt(6)
    .p2align 3
    v_pk_mul_f32 v[148:149], v[148:149], v[238:239]
    v_pk_mul_f32 v[250:251], v[250:251], v[252:253]
    v_pk_mul_f32 v[248:249], v[248:249], v[252:253]
    v_pk_mul_f32 v[150:151], v[150:151], v[236:237]
    v_pk_mul_f32 v[232:233], v[144:145], v[250:251]
    v_pk_mul_f32 v[234:235], v[146:147], v[250:251]
    v_pk_mul_f32 v[236:237], v[148:149], v[248:249]
    v_pk_mul_f32 v[238:239], v[150:151], v[248:249]
    v_cvt_pk_bf16_f32 v36, v232, v233
    v_cvt_pk_bf16_f32 v38, v236, v237
    v_cvt_pk_bf16_f32 v37, v234, v235
    v_cvt_pk_bf16_f32 v39, v238, v239
    v_permlane16_swap_b32 v36, v38
    v_bfi_b32 v240, s48, v0, v36
    v_permlane16_swap_b32 v37, v39
    v_bfi_b32 v242, s48, v0, v38
    v_bfi_b32 v241, s48, v7, v37
    v_bfi_b32 v243, s48, v7, v39
    .p2align 3
    v_pk_fma_f32 v[232:233], v[192:193], v[10:11], v[196:197] op_sel:[0,1,0] op_sel_hi:[1,1,1] neg_lo:[1,0,0] neg_hi:[1,0,0]
    v_pk_fma_f32 v[234:235], v[194:195], v[10:11], v[198:199] op_sel:[0,1,0] op_sel_hi:[1,1,1] neg_lo:[1,0,0] neg_hi:[1,0,0]
    v_pk_fma_f32 v[236:237], v[192:193], v[12:13], v[196:197] op_sel:[0,1,0] op_sel_hi:[1,1,1] neg_lo:[1,0,0] neg_hi:[1,0,0]
    v_pk_fma_f32 v[238:239], v[194:195], v[12:13], v[198:199] op_sel:[0,1,0] op_sel_hi:[1,1,1] neg_lo:[1,0,0] neg_hi:[1,0,0]
    buffer_store_dwordx4 v[240:243], v3, s[4:7], s31 offen offset:2048 sc1
    ds_read_b128 v[184:187], v24 offset:256
    ds_read_b128 v[188:191], v24 offset:768
    v_pk_fma_f32 v[152:153], v[152:153], v[10:11], v[232:233] op_sel_hi:[1,0,1]
    v_pk_fma_f32 v[154:155], v[154:155], v[10:11], v[234:235] op_sel_hi:[1,0,1]
    v_pk_fma_f32 v[156:157], v[156:157], v[12:13], v[236:237] op_sel_hi:[1,0,1]
    v_pk_fma_f32 v[158:159], v[158:159], v[12:13], v[238:239] op_sel_hi:[1,0,1]
    v_pk_mul_f32 v[232:233], v[152:153], v[152:153]
    v_pk_mul_f32 v[234:235], v[154:155], v[154:155]
    v_pk_mul_f32 v[236:237], v[156:157], v[156:157]
    v_pk_mul_f32 v[238:239], v[158:159], v[158:159]
    v_pk_fma_f32 v[232:233], v[232:233], v[14:15], v[14:15] op_sel:[0,0,1] op_sel_hi:[1,0,1]
    v_pk_fma_f32 v[234:235], v[234:235], v[14:15], v[14:15] op_sel:[0,0,1] op_sel_hi:[1,0,1]
    v_pk_fma_f32 v[236:237], v[236:237], v[14:15], v[14:15] op_sel:[0,0,1] op_sel_hi:[1,0,1]
    v_pk_fma_f32 v[238:239], v[238:239], v[14:15], v[14:15] op_sel:[0,0,1] op_sel_hi:[1,0,1]
    v_pk_fma_f32 v[232:233], v[232:233], v[152:153], v[16:17] op_sel:[0,0,1] op_sel_hi:[1,1,1]
    v_pk_fma_f32 v[234:235], v[234:235], v[154:155], v[16:17] op_sel:[0,0,1] op_sel_hi:[1,1,1]
    v_pk_fma_f32 v[236:237], v[236:237], v[156:157], v[16:17] op_sel:[0,0,1] op_sel_hi:[1,1,1]
    v_pk_fma_f32 v[238:239], v[238:239], v[158:159], v[16:17] op_sel:[0,0,1] op_sel_hi:[1,1,1]
    s_waitcnt lgkmcnt(2)
    v_smfmac_f32_16x16x64_bf16 v[168:171], v[80:83], v[104:111], v4
    ds_read_b64_tr_b16 v[64:65], v19 offset:3136
    v_exp_f32_e64 v232, v232 clamp
    v_smfmac_f32_16x16x64_bf16 v[172:175], v[80:83], v[104:111], v4 abid:1
    ds_read_b64_tr_b16 v[66:67], v19 offset:4672
    v_exp_f32_e64 v233, v233 clamp
    v_smfmac_f32_16x16x64_bf16 v[168:171], v[84:87], v[112:119], v4
    ds_read_b64_tr_b16 v[68:69], v19 offset:6208
    v_exp_f32_e64 v234, v234 clamp
    v_smfmac_f32_16x16x64_bf16 v[172:175], v[84:87], v[112:119], v4 abid:1
    ds_read_b64_tr_b16 v[70:71], v19 offset:7744
    v_exp_f32_e64 v235, v235 clamp
    v_smfmac_f32_16x16x64_bf16 v[168:171], v[88:91], v[120:127], v4
    ds_read_b64_tr_b16 v[72:73], v19 offset:9280
    v_exp_f32_e64 v236, v236 clamp
    v_smfmac_f32_16x16x64_bf16 v[172:175], v[88:91], v[120:127], v4 abid:1
    ds_read_b64_tr_b16 v[74:75], v19 offset:10816
    v_exp_f32_e64 v237, v237 clamp
    v_exp_f32_e64 v238, v238 clamp
    v_exp_f32_e64 v239, v239 clamp
    .p2align 3
    v_pk_add_f32 v[232:233], v[232:233], v[16:17] op_sel_hi:[1,0]
    v_pk_add_f32 v[234:235], v[234:235], v[16:17] op_sel_hi:[1,0]
    v_pk_add_f32 v[236:237], v[236:237], v[16:17] op_sel_hi:[1,0]
    v_pk_add_f32 v[238:239], v[238:239], v[16:17] op_sel_hi:[1,0]
    v_pk_mul_f32 v[248:249], v[232:233], v[234:235]
    v_pk_mul_f32 v[250:251], v[236:237], v[238:239]
    v_pk_mul_f32 v[152:153], v[152:153], v[234:235]
    v_pk_mul_f32 v[252:253], v[248:249], v[250:251]
    v_pk_mul_f32 v[154:155], v[154:155], v[232:233]
    v_rcp_f32 v252, v252
    v_rcp_f32_e64 v253, v253
    s_waitcnt lgkmcnt(6)
    .p2align 3
    v_pk_mul_f32 v[156:157], v[156:157], v[238:239]
    v_pk_mul_f32 v[250:251], v[250:251], v[252:253]
    v_pk_mul_f32 v[248:249], v[248:249], v[252:253]
    v_pk_mul_f32 v[158:159], v[158:159], v[236:237]
    v_pk_mul_f32 v[232:233], v[152:153], v[250:251]
    v_pk_mul_f32 v[234:235], v[154:155], v[250:251]
    v_pk_mul_f32 v[236:237], v[156:157], v[248:249]
    v_pk_mul_f32 v[238:239], v[158:159], v[248:249]
    v_cvt_pk_bf16_f32 v40, v232, v233
    v_cvt_pk_bf16_f32 v42, v236, v237
    v_cvt_pk_bf16_f32 v41, v234, v235
    v_cvt_pk_bf16_f32 v43, v238, v239
    v_permlane16_swap_b32 v40, v42
    v_bfi_b32 v244, s48, v0, v40
    v_permlane16_swap_b32 v41, v43
    v_bfi_b32 v246, s48, v0, v42
    v_bfi_b32 v245, s48, v7, v41
    v_bfi_b32 v247, s48, v7, v43
    .p2align 3
    v_pk_fma_f32 v[232:233], v[184:185], v[10:11], v[188:189] op_sel:[0,1,0] op_sel_hi:[1,1,1] neg_lo:[1,0,0] neg_hi:[1,0,0]
    v_pk_fma_f32 v[234:235], v[186:187], v[10:11], v[190:191] op_sel:[0,1,0] op_sel_hi:[1,1,1] neg_lo:[1,0,0] neg_hi:[1,0,0]
    v_pk_fma_f32 v[236:237], v[184:185], v[12:13], v[188:189] op_sel:[0,1,0] op_sel_hi:[1,1,1] neg_lo:[1,0,0] neg_hi:[1,0,0]
    v_pk_fma_f32 v[238:239], v[186:187], v[12:13], v[190:191] op_sel:[0,1,0] op_sel_hi:[1,1,1] neg_lo:[1,0,0] neg_hi:[1,0,0]
    buffer_store_dwordx4 v[244:247], v3, s[4:7], s31 offen offset:3072 sc1
    ds_read_b128 v[192:195], v24 offset:320
    ds_read_b128 v[196:199], v24 offset:832
    v_pk_fma_f32 v[160:161], v[160:161], v[10:11], v[232:233] op_sel_hi:[1,0,1]
    v_pk_fma_f32 v[162:163], v[162:163], v[10:11], v[234:235] op_sel_hi:[1,0,1]
    v_pk_fma_f32 v[164:165], v[164:165], v[12:13], v[236:237] op_sel_hi:[1,0,1]
    v_pk_fma_f32 v[166:167], v[166:167], v[12:13], v[238:239] op_sel_hi:[1,0,1]
    v_pk_mul_f32 v[232:233], v[160:161], v[160:161]
    v_pk_mul_f32 v[234:235], v[162:163], v[162:163]
    v_pk_mul_f32 v[236:237], v[164:165], v[164:165]
    v_pk_mul_f32 v[238:239], v[166:167], v[166:167]
    v_pk_fma_f32 v[232:233], v[232:233], v[14:15], v[14:15] op_sel:[0,0,1] op_sel_hi:[1,0,1]
    v_pk_fma_f32 v[234:235], v[234:235], v[14:15], v[14:15] op_sel:[0,0,1] op_sel_hi:[1,0,1]
    v_pk_fma_f32 v[236:237], v[236:237], v[14:15], v[14:15] op_sel:[0,0,1] op_sel_hi:[1,0,1]
    v_pk_fma_f32 v[238:239], v[238:239], v[14:15], v[14:15] op_sel:[0,0,1] op_sel_hi:[1,0,1]
    v_pk_fma_f32 v[232:233], v[232:233], v[160:161], v[16:17] op_sel:[0,0,1] op_sel_hi:[1,1,1]
    v_pk_fma_f32 v[234:235], v[234:235], v[162:163], v[16:17] op_sel:[0,0,1] op_sel_hi:[1,1,1]
    v_pk_fma_f32 v[236:237], v[236:237], v[164:165], v[16:17] op_sel:[0,0,1] op_sel_hi:[1,1,1]
    v_pk_fma_f32 v[238:239], v[238:239], v[166:167], v[16:17] op_sel:[0,0,1] op_sel_hi:[1,1,1]
    s_waitcnt lgkmcnt(2)
    v_smfmac_f32_16x16x64_bf16 v[176:179], v[64:67], v[104:111], v4
    ds_read_b64_tr_b16 v[200:201], v57 offset:0
    ds_read_b64_tr_b16 v[202:203], v57 offset:1024
    v_exp_f32_e64 v232, v232 clamp
    v_smfmac_f32_16x16x64_bf16 v[180:183], v[64:67], v[104:111], v4 abid:1
    ds_read_b64_tr_b16 v[204:205], v58 offset:0
    ds_read_b64_tr_b16 v[206:207], v58 offset:1024
    v_exp_f32_e64 v233, v233 clamp
    v_smfmac_f32_16x16x64_bf16 v[176:179], v[68:71], v[112:119], v4
    ds_read_b64_tr_b16 v[208:209], v59 offset:0
    ds_read_b64_tr_b16 v[210:211], v59 offset:1024
    v_exp_f32_e64 v234, v234 clamp
    v_smfmac_f32_16x16x64_bf16 v[180:183], v[68:71], v[112:119], v4 abid:1
    ds_read_b64_tr_b16 v[212:213], v57 offset:4096
    ds_read_b64_tr_b16 v[214:215], v57 offset:5120
    v_exp_f32_e64 v235, v235 clamp
    v_smfmac_f32_16x16x64_bf16 v[176:179], v[72:75], v[120:127], v4
    ds_read_b64_tr_b16 v[216:217], v58 offset:4096
    ds_read_b64_tr_b16 v[218:219], v58 offset:5120
    v_exp_f32_e64 v236, v236 clamp
    v_smfmac_f32_16x16x64_bf16 v[180:183], v[72:75], v[120:127], v4 abid:1
    ds_read_b64_tr_b16 v[220:221], v59 offset:4096
    ds_read_b64_tr_b16 v[222:223], v59 offset:5120
    v_exp_f32_e64 v237, v237 clamp
    v_exp_f32_e64 v238, v238 clamp
    v_exp_f32_e64 v239, v239 clamp
    .p2align 3
    v_pk_add_f32 v[232:233], v[232:233], v[16:17] op_sel_hi:[1,0]
    v_pk_add_f32 v[234:235], v[234:235], v[16:17] op_sel_hi:[1,0]
    v_pk_add_f32 v[236:237], v[236:237], v[16:17] op_sel_hi:[1,0]
    v_pk_add_f32 v[238:239], v[238:239], v[16:17] op_sel_hi:[1,0]
    v_pk_mul_f32 v[248:249], v[232:233], v[234:235]
    v_pk_mul_f32 v[250:251], v[236:237], v[238:239]
    v_pk_mul_f32 v[160:161], v[160:161], v[234:235]
    v_pk_mul_f32 v[252:253], v[248:249], v[250:251]
    v_pk_mul_f32 v[162:163], v[162:163], v[232:233]
    v_rcp_f32 v252, v252
    v_rcp_f32_e64 v253, v253
    s_waitcnt lgkmcnt(12)
    .p2align 3
    v_pk_mul_f32 v[164:165], v[164:165], v[238:239]
    v_pk_mul_f32 v[250:251], v[250:251], v[252:253]
    v_pk_mul_f32 v[248:249], v[248:249], v[252:253]
    v_pk_mul_f32 v[166:167], v[166:167], v[236:237]
    v_pk_mul_f32 v[232:233], v[160:161], v[250:251]
    v_pk_mul_f32 v[234:235], v[162:163], v[250:251]
    v_pk_mul_f32 v[236:237], v[164:165], v[248:249]
    v_pk_mul_f32 v[238:239], v[166:167], v[248:249]
    v_cvt_pk_bf16_f32 v44, v232, v233
    v_cvt_pk_bf16_f32 v46, v236, v237
    v_cvt_pk_bf16_f32 v45, v234, v235
    v_cvt_pk_bf16_f32 v47, v238, v239
    v_permlane16_swap_b32 v44, v46
    v_bfi_b32 v240, s48, v0, v44
    v_permlane16_swap_b32 v45, v47
    v_bfi_b32 v242, s48, v0, v46
    v_bfi_b32 v241, s48, v7, v45
    v_bfi_b32 v243, s48, v7, v47
    .p2align 3
    v_pk_fma_f32 v[232:233], v[192:193], v[10:11], v[196:197] op_sel:[0,1,0] op_sel_hi:[1,1,1] neg_lo:[1,0,0] neg_hi:[1,0,0]
    v_pk_fma_f32 v[234:235], v[194:195], v[10:11], v[198:199] op_sel:[0,1,0] op_sel_hi:[1,1,1] neg_lo:[1,0,0] neg_hi:[1,0,0]
    v_pk_fma_f32 v[236:237], v[192:193], v[12:13], v[196:197] op_sel:[0,1,0] op_sel_hi:[1,1,1] neg_lo:[1,0,0] neg_hi:[1,0,0]
    v_pk_fma_f32 v[238:239], v[194:195], v[12:13], v[198:199] op_sel:[0,1,0] op_sel_hi:[1,1,1] neg_lo:[1,0,0] neg_hi:[1,0,0]
    buffer_store_dwordx4 v[240:243], v2, s[4:7], s31 offen offset:0 sc1
    ds_read_b128 v[184:187], v24 offset:384
    ds_read_b128 v[188:191], v24 offset:896
    v_pk_fma_f32 v[168:169], v[168:169], v[10:11], v[232:233] op_sel_hi:[1,0,1]
    v_pk_fma_f32 v[170:171], v[170:171], v[10:11], v[234:235] op_sel_hi:[1,0,1]
    v_pk_fma_f32 v[172:173], v[172:173], v[12:13], v[236:237] op_sel_hi:[1,0,1]
    v_pk_fma_f32 v[174:175], v[174:175], v[12:13], v[238:239] op_sel_hi:[1,0,1]
    v_pk_mul_f32 v[232:233], v[168:169], v[168:169]
    v_pk_mul_f32 v[234:235], v[170:171], v[170:171]
    v_pk_mul_f32 v[236:237], v[172:173], v[172:173]
    v_pk_mul_f32 v[238:239], v[174:175], v[174:175]
    v_pk_fma_f32 v[232:233], v[232:233], v[14:15], v[14:15] op_sel:[0,0,1] op_sel_hi:[1,0,1]
    v_pk_fma_f32 v[234:235], v[234:235], v[14:15], v[14:15] op_sel:[0,0,1] op_sel_hi:[1,0,1]
    v_pk_fma_f32 v[236:237], v[236:237], v[14:15], v[14:15] op_sel:[0,0,1] op_sel_hi:[1,0,1]
    v_pk_fma_f32 v[238:239], v[238:239], v[14:15], v[14:15] op_sel:[0,0,1] op_sel_hi:[1,0,1]
    v_pk_fma_f32 v[232:233], v[232:233], v[168:169], v[16:17] op_sel:[0,0,1] op_sel_hi:[1,1,1]
    v_pk_fma_f32 v[234:235], v[234:235], v[170:171], v[16:17] op_sel:[0,0,1] op_sel_hi:[1,1,1]
    v_pk_fma_f32 v[236:237], v[236:237], v[172:173], v[16:17] op_sel:[0,0,1] op_sel_hi:[1,1,1]
    v_pk_fma_f32 v[238:239], v[238:239], v[174:175], v[16:17] op_sel:[0,0,1] op_sel_hi:[1,1,1]
    v_exp_f32_e64 v232, v232 clamp
    v_exp_f32_e64 v233, v233 clamp
    v_exp_f32_e64 v234, v234 clamp
    v_exp_f32_e64 v235, v235 clamp
    v_exp_f32_e64 v236, v236 clamp
    v_exp_f32_e64 v237, v237 clamp
    v_exp_f32_e64 v238, v238 clamp
    v_exp_f32_e64 v239, v239 clamp
    .p2align 3
    v_pk_add_f32 v[232:233], v[232:233], v[16:17] op_sel_hi:[1,0]
    v_pk_add_f32 v[234:235], v[234:235], v[16:17] op_sel_hi:[1,0]
    v_pk_add_f32 v[236:237], v[236:237], v[16:17] op_sel_hi:[1,0]
    v_pk_add_f32 v[238:239], v[238:239], v[16:17] op_sel_hi:[1,0]
    v_pk_mul_f32 v[248:249], v[232:233], v[234:235]
    v_pk_mul_f32 v[250:251], v[236:237], v[238:239]
    v_pk_mul_f32 v[168:169], v[168:169], v[234:235]
    v_pk_mul_f32 v[252:253], v[248:249], v[250:251]
    v_pk_mul_f32 v[170:171], v[170:171], v[232:233]
    v_rcp_f32 v252, v252
    v_rcp_f32_e64 v253, v253
    s_waitcnt lgkmcnt(0)
    .p2align 3
    v_pk_mul_f32 v[172:173], v[172:173], v[238:239]
    v_pk_mul_f32 v[250:251], v[250:251], v[252:253]
    v_pk_mul_f32 v[248:249], v[248:249], v[252:253]
    v_pk_mul_f32 v[174:175], v[174:175], v[236:237]
    v_pk_mul_f32 v[232:233], v[168:169], v[250:251]
    v_pk_mul_f32 v[234:235], v[170:171], v[250:251]
    v_pk_mul_f32 v[236:237], v[172:173], v[248:249]
    v_pk_mul_f32 v[238:239], v[174:175], v[248:249]
    v_cvt_pk_bf16_f32 v48, v232, v233
    v_cvt_pk_bf16_f32 v50, v236, v237
    v_cvt_pk_bf16_f32 v49, v234, v235
    v_cvt_pk_bf16_f32 v51, v238, v239
    v_permlane16_swap_b32 v48, v50
    v_bfi_b32 v244, s48, v0, v48
    v_permlane16_swap_b32 v49, v51
    v_bfi_b32 v246, s48, v0, v50
    v_bfi_b32 v245, s48, v7, v49
    v_bfi_b32 v247, s48, v7, v51
    .p2align 3
    v_pk_fma_f32 v[232:233], v[184:185], v[10:11], v[188:189] op_sel:[0,1,0] op_sel_hi:[1,1,1] neg_lo:[1,0,0] neg_hi:[1,0,0]
    v_pk_fma_f32 v[234:235], v[186:187], v[10:11], v[190:191] op_sel:[0,1,0] op_sel_hi:[1,1,1] neg_lo:[1,0,0] neg_hi:[1,0,0]
    v_pk_fma_f32 v[236:237], v[184:185], v[12:13], v[188:189] op_sel:[0,1,0] op_sel_hi:[1,1,1] neg_lo:[1,0,0] neg_hi:[1,0,0]
    v_pk_fma_f32 v[238:239], v[186:187], v[12:13], v[190:191] op_sel:[0,1,0] op_sel_hi:[1,1,1] neg_lo:[1,0,0] neg_hi:[1,0,0]
    buffer_store_dwordx4 v[244:247], v2, s[4:7], s31 offen offset:1024 sc1
    v_pk_fma_f32 v[176:177], v[176:177], v[10:11], v[232:233] op_sel_hi:[1,0,1]
    v_pk_fma_f32 v[178:179], v[178:179], v[10:11], v[234:235] op_sel_hi:[1,0,1]
    v_pk_fma_f32 v[180:181], v[180:181], v[12:13], v[236:237] op_sel_hi:[1,0,1]
    s_branch S_2o
S_2:
    s_branch S_back
S_2o:
    v_pk_fma_f32 v[182:183], v[182:183], v[12:13], v[238:239] op_sel_hi:[1,0,1]
    v_pk_mul_f32 v[232:233], v[176:177], v[176:177]
    v_pk_mul_f32 v[234:235], v[178:179], v[178:179]
    v_pk_mul_f32 v[236:237], v[180:181], v[180:181]
    v_pk_mul_f32 v[238:239], v[182:183], v[182:183]
    v_pk_fma_f32 v[232:233], v[232:233], v[14:15], v[14:15] op_sel:[0,0,1] op_sel_hi:[1,0,1]
    v_pk_fma_f32 v[234:235], v[234:235], v[14:15], v[14:15] op_sel:[0,0,1] op_sel_hi:[1,0,1]
    v_pk_fma_f32 v[236:237], v[236:237], v[14:15], v[14:15] op_sel:[0,0,1] op_sel_hi:[1,0,1]
    v_pk_fma_f32 v[238:239], v[238:239], v[14:15], v[14:15] op_sel:[0,0,1] op_sel_hi:[1,0,1]
    v_pk_fma_f32 v[232:233], v[232:233], v[176:177], v[16:17] op_sel:[0,0,1] op_sel_hi:[1,1,1]
    v_pk_fma_f32 v[234:235], v[234:235], v[178:179], v[16:17] op_sel:[0,0,1] op_sel_hi:[1,1,1]
    v_pk_fma_f32 v[236:237], v[236:237], v[180:181], v[16:17] op_sel:[0,0,1] op_sel_hi:[1,1,1]
    v_pk_fma_f32 v[238:239], v[238:239], v[182:183], v[16:17] op_sel:[0,0,1] op_sel_hi:[1,1,1]
    v_mfma_f32_32x32x16_bf16 v[64:79], v[200:203], v[28:31], 0
    ds_read_b64_tr_b16 v[224:225], v57 offset:8192
    ds_read_b64_tr_b16 v[226:227], v57 offset:9216
    v_exp_f32_e64 v232, v232 clamp
    v_exp_f32_e64 v233, v233 clamp
    v_mfma_f32_32x32x16_bf16 v[80:95], v[204:207], v[28:31], 0
    ds_read_b64_tr_b16 v[228:229], v58 offset:8192
    ds_read_b64_tr_b16 v[230:231], v58 offset:9216
    v_exp_f32_e64 v234, v234 clamp
    v_exp_f32_e64 v235, v235 clamp
    v_mfma_f32_32x32x16_bf16 v[96:111], v[208:211], v[28:31], 0
    ds_read_b64_tr_b16 v[200:201], v59 offset:8192
    ds_read_b64_tr_b16 v[202:203], v59 offset:9216
    v_exp_f32_e64 v236, v236 clamp
    v_exp_f32_e64 v237, v237 clamp
    v_exp_f32_e64 v238, v238 clamp
    v_exp_f32_e64 v239, v239 clamp
    .p2align 3
    v_pk_add_f32 v[232:233], v[232:233], v[16:17] op_sel_hi:[1,0]
    v_pk_add_f32 v[234:235], v[234:235], v[16:17] op_sel_hi:[1,0]
    v_pk_add_f32 v[236:237], v[236:237], v[16:17] op_sel_hi:[1,0]
    v_pk_add_f32 v[238:239], v[238:239], v[16:17] op_sel_hi:[1,0]
    v_pk_mul_f32 v[248:249], v[232:233], v[234:235]
    v_pk_mul_f32 v[250:251], v[236:237], v[238:239]
    v_pk_mul_f32 v[176:177], v[176:177], v[234:235]
    v_pk_mul_f32 v[252:253], v[248:249], v[250:251]
    v_pk_mul_f32 v[178:179], v[178:179], v[232:233]
    v_rcp_f32 v252, v252
    v_rcp_f32 v253, v253
    .p2align 3
    v_pk_mul_f32 v[180:181], v[180:181], v[238:239]
    v_pk_mul_f32 v[250:251], v[250:251], v[252:253]
    v_pk_mul_f32 v[248:249], v[248:249], v[252:253]
    v_pk_mul_f32 v[182:183], v[182:183], v[236:237]
    v_pk_mul_f32 v[232:233], v[176:177], v[250:251]
    v_pk_mul_f32 v[234:235], v[178:179], v[250:251]
    v_pk_mul_f32 v[236:237], v[180:181], v[248:249]
    v_pk_mul_f32 v[238:239], v[182:183], v[248:249]
    v_cvt_pk_bf16_f32 v52, v232, v233
    v_cvt_pk_bf16_f32 v54, v236, v237
    v_cvt_pk_bf16_f32 v53, v234, v235
    v_cvt_pk_bf16_f32 v55, v238, v239
    v_permlane16_swap_b32 v52, v54
    v_bfi_b32 v240, s48, v0, v52
    v_permlane16_swap_b32 v53, v55
    v_bfi_b32 v242, s48, v0, v54
    v_bfi_b32 v241, s48, v7, v53
    v_bfi_b32 v243, s48, v7, v55
    buffer_store_dwordx4 v[240:243], v2, s[4:7], s31 offen offset:2048 sc1
    v_mfma_f32_32x32x16_bf16 v[64:79], v[212:215], v[32:35], v[64:79]
    ds_read_b64_tr_b16 v[204:205], v57 offset:12288
    ds_read_b64_tr_b16 v[206:207], v57 offset:13312
    v_mov_b32 v13, 0xffff0000
    v_mfma_f32_32x32x16_bf16 v[80:95], v[216:219], v[32:35], v[80:95]
    ds_read_b64_tr_b16 v[208:209], v58 offset:12288
    ds_read_b64_tr_b16 v[210:211], v58 offset:13312
    ds_read_b128 v[112:115], v5 offset:0
    v_mfma_f32_32x32x16_bf16 v[96:111], v[220:223], v[32:35], v[96:111]
    ds_read_b64_tr_b16 v[212:213], v59 offset:12288
    ds_read_b64_tr_b16 v[214:215], v59 offset:13312
    buffer_load_dwordx4 v[128:131], v3, s[4:7], s37 offen offset:0 sc1
    s_waitcnt lgkmcnt(9)
    v_mfma_f32_32x32x16_bf16 v[64:79], v[224:227], v[36:39], v[64:79]
    ds_read_b64_tr_b16 v[216:217], v57 offset:16384
    ds_read_b64_tr_b16 v[218:219], v57 offset:17408
    buffer_load_dwordx4 v[132:135], v3, s[4:7], s38 offen offset:0 sc1
    v_mfma_f32_32x32x16_bf16 v[80:95], v[228:231], v[36:39], v[80:95]
    ds_read_b64_tr_b16 v[220:221], v58 offset:16384
    ds_read_b64_tr_b16 v[222:223], v58 offset:17408
    buffer_load_dwordx4 v[136:139], v3, s[4:7], s39 offen offset:0 sc1
    s_waitcnt lgkmcnt(9)
    v_mfma_f32_32x32x16_bf16 v[96:111], v[200:203], v[36:39], v[96:111]
    ds_read_b64_tr_b16 v[224:225], v59 offset:16384
    ds_read_b64_tr_b16 v[226:227], v59 offset:17408
    ds_read_b128 v[116:119], v5 offset:16
    v_mfma_f32_32x32x16_bf16 v[64:79], v[204:207], v[40:43], v[64:79]
    ds_read_b64_tr_b16 v[228:229], v57 offset:20480
    ds_read_b64_tr_b16 v[230:231], v57 offset:21504
    buffer_load_dwordx4 v[140:143], v3, s[4:7], s37 offen offset:1024 sc1
    s_waitcnt lgkmcnt(9)
    v_mfma_f32_32x32x16_bf16 v[80:95], v[208:211], v[40:43], v[80:95]
    ds_read_b64_tr_b16 v[200:201], v58 offset:20480
    ds_read_b64_tr_b16 v[202:203], v58 offset:21504
    buffer_load_dwordx4 v[144:147], v3, s[4:7], s38 offen offset:1024 sc1
    ds_read_b32 v9, v26
    v_mfma_f32_32x32x16_bf16 v[96:111], v[212:215], v[40:43], v[96:111]
    ds_read_b64_tr_b16 v[204:205], v59 offset:20480
    ds_read_b64_tr_b16 v[206:207], v59 offset:21504
    buffer_load_dwordx4 v[148:151], v3, s[4:7], s39 offen offset:1024 sc1
    s_waitcnt lgkmcnt(10)
    v_mfma_f32_32x32x16_bf16 v[64:79], v[216:219], v[44:47], v[64:79]
    ds_read_b64_tr_b16 v[208:209], v57 offset:24576
    ds_read_b64_tr_b16 v[210:211], v57 offset:25600
    ds_read_b128 v[120:123], v5 offset:64
    v_mfma_f32_32x32x16_bf16 v[80:95], v[220:223], v[44:47], v[80:95]
    ds_read_b64_tr_b16 v[212:213], v58 offset:24576
    ds_read_b64_tr_b16 v[214:215], v58 offset:25600
    ds_read_b128 v[124:127], v5 offset:80
    s_waitcnt lgkmcnt(8)
    v_cmp_eq_u32 vcc, 0, v9
    v_mfma_f32_32x32x16_bf16 v[96:111], v[224:227], v[44:47], v[96:111]
    ds_read_b64_tr_b16 v[216:217], v59 offset:24576
    ds_read_b64_tr_b16 v[218:219], v59 offset:25600
    buffer_load_dwordx4 v[152:155], v3, s[4:7], s37 offen offset:2048 sc1
    s_cbranch_vccnz R_fg
B_fg:
    v_mfma_f32_32x32x16_bf16 v[64:79], v[228:231], v[48:51], v[64:79]
    ds_read_b64_tr_b16 v[220:221], v57 offset:28672
    ds_read_b64_tr_b16 v[222:223], v57 offset:29696
    buffer_load_dwordx4 v[156:159], v3, s[4:7], s38 offen offset:2048 sc1
    s_waitcnt lgkmcnt(10)
    v_mfma_f32_32x32x16_bf16 v[80:95], v[200:203], v[48:51], v[80:95]
    ds_read_b64_tr_b16 v[224:225], v58 offset:28672
    ds_read_b64_tr_b16 v[226:227], v58 offset:29696
    buffer_load_dwordx4 v[160:163], v3, s[4:7], s39 offen offset:2048 sc1
    v_mfma_f32_32x32x16_bf16 v[96:111], v[204:207], v[48:51], v[96:111]
    ds_read_b64_tr_b16 v[228:229], v59 offset:28672
    ds_read_b64_tr_b16 v[230:231], v59 offset:29696
    s_waitcnt vmcnt(6)
    v_bitop3_b32 v8, v128, v130, v0 bitop3:0x7e
    v_bitop3_b32 v9, v129, v131, v7 bitop3:0x7e
    v_bitop3_b32 v21, v132, v134, v0 bitop3:0x7e
    s_waitcnt lgkmcnt(9)
    v_mfma_f32_32x32x16_bf16 v[64:79], v[208:211], v[52:55], v[64:79]
    ds_read_b64_tr_b16 v[200:201], v61 offset:0
    ds_read_b64_tr_b16 v[202:203], v61 offset:1024
    v_or3_b32 v8, v8, v9, v21
    v_bitop3_b32 v9, v133, v135, v7 bitop3:0x7e
    v_bitop3_b32 v21, v136, v138, v0 bitop3:0x7e
    v_or3_b32 v8, v8, v9, v21
    v_mfma_f32_32x32x16_bf16 v[80:95], v[212:215], v[52:55], v[80:95]
    ds_read_b64_tr_b16 v[204:205], v62 offset:0
    ds_read_b64_tr_b16 v[206:207], v62 offset:1024
    buffer_load_dwordx4 v[164:167], v3, s[4:7], s37 offen offset:3072 sc1
    v_bitop3_b32 v9, v137, v139, v7 bitop3:0x7e
    v_bitop3_b32 v8, v8, v9, s48 bitop3:0xa8
    v_cmp_ne_u32 vcc, 0, v8
    s_waitcnt lgkmcnt(8)
    v_mfma_f32_32x32x16_bf16 v[96:111], v[216:219], v[52:55], v[96:111]
    ds_read_b64_tr_b16 v[208:209], v63 offset:0
    ds_read_b64_tr_b16 v[210:211], v63 offset:1024
    buffer_load_dwordx4 v[168:171], v3, s[4:7], s38 offen offset:3072 sc1
    s_cbranch_vccnz R_q0
B_q0:
    v_mfma_f32_32x32x16_bf16 v[64:79], v[220:223], v[128:131], v[64:79]
    ds_read_b64_tr_b16 v[212:213], v61 offset:28672
    ds_read_b64_tr_b16 v[214:215], v61 offset:29696
    buffer_load_dwordx4 v[172:175], v3, s[4:7], s39 offen offset:3072 sc1
    s_waitcnt lgkmcnt(8)
    v_mfma_f32_32x32x16_bf16 v[80:95], v[224:227], v[128:131], v[80:95]
    ds_read_b64_tr_b16 v[216:217], v62 offset:28672
    ds_read_b64_tr_b16 v[218:219], v62 offset:29696
    v_mfma_f32_32x32x16_bf16 v[96:111], v[228:231], v[128:131], v[96:111]
    ds_read_b64_tr_b16 v[220:221], v63 offset:28672
    ds_read_b64_tr_b16 v[222:223], v63 offset:29696
    s_waitcnt lgkmcnt(8)
    v_mfma_f32_32x32x16_bf16 v[64:79], v[200:203], v[132:135], v[64:79]
    ds_read_b64_tr_b16 v[224:225], v57 offset:32768
    ds_read_b64_tr_b16 v[226:227], v57 offset:33792
    buffer_load_dwordx4 v[176:179], v2, s[4:7], s37 offen offset:0 sc1
    v_mfma_f32_32x32x16_bf16 v[80:95], v[204:207], v[132:135], v[80:95]
    ds_read_b64_tr_b16 v[228:229], v58 offset:32768
    ds_read_b64_tr_b16 v[230:231], v58 offset:33792
    buffer_load_dwordx4 v[180:183], v2, s[4:7], s38 offen offset:0 sc1
    s_waitcnt lgkmcnt(8)
    v_mfma_f32_32x32x16_bf16 v[96:111], v[208:211], v[132:135], v[96:111]
    ds_read_b64_tr_b16 v[200:201], v59 offset:32768
    ds_read_b64_tr_b16 v[202:203], v59 offset:33792
    buffer_load_dwordx4 v[184:187], v2, s[4:7], s39 offen offset:0 sc1
    s_waitcnt vmcnt(9)
    v_bitop3_b32 v8, v140, v142, v0 bitop3:0x7e
    v_bitop3_b32 v9, v141, v143, v7 bitop3:0x7e
    v_bitop3_b32 v21, v144, v146, v0 bitop3:0x7e
    v_mfma_f32_32x32x16_bf16 v[64:79], v[212:215], v[136:139], v[64:79]
    ds_read_b64_tr_b16 v[204:205], v61 offset:4096
    ds_read_b64_tr_b16 v[206:207], v61 offset:5120
    v_or3_b32 v8, v8, v9, v21
    v_bitop3_b32 v9, v145, v147, v7 bitop3:0x7e
    v_bitop3_b32 v21, v148, v150, v0 bitop3:0x7e
    v_or3_b32 v8, v8, v9, v21
    s_waitcnt lgkmcnt(8)
    v_mfma_f32_32x32x16_bf16 v[80:95], v[216:219], v[136:139], v[80:95]
    ds_read_b64_tr_b16 v[208:209], v62 offset:4096
    ds_read_b64_tr_b16 v[210:211], v62 offset:5120
    v_bitop3_b32 v9, v149, v151, v7 bitop3:0x7e
    v_bitop3_b32 v8, v8, v9, s48 bitop3:0xa8
    v_cmp_ne_u32 vcc, 0, v8
    ds_read_b32 v6, v26
    v_mfma_f32_32x32x16_bf16 v[96:111], v[220:223], v[136:139], v[96:111]
    ds_read_b64_tr_b16 v[212:213], v63 offset:4096
    ds_read_b64_tr_b16 v[214:215], v63 offset:5120
    buffer_load_dwordx4 v[188:191], v2, s[4:7], s37 offen offset:1024 sc1
    s_cbranch_vccnz R_q1
B_q1:
    s_waitcnt lgkmcnt(9)
    v_mfma_f32_32x32x16_bf16 v[64:79], v[224:227], v[140:143], v[64:79]
    ds_read_b64_tr_b16 v[216:217], v61 offset:32768
    ds_read_b64_tr_b16 v[218:219], v61 offset:33792
    buffer_load_dwordx4 v[192:195], v2, s[4:7], s38 offen offset:1024 sc1
    v_mfma_f32_32x32x16_bf16 v[80:95], v[228:231], v[140:143], v[80:95]
    ds_read_b64_tr_b16 v[220:221], v62 offset:32768
    ds_read_b64_tr_b16 v[222:223], v62 offset:33792
    buffer_load_dwordx4 v[196:199], v2, s[4:7], s39 offen offset:1024 sc1
    s_waitcnt lgkmcnt(6)
    v_cmp_ne_u32 vcc, -1, v6
    v_mfma_f32_32x32x16_bf16 v[96:111], v[200:203], v[140:143], v[96:111]
    ds_read_b64_tr_b16 v[224:225], v63 offset:32768
    ds_read_b64_tr_b16 v[226:227], v63 offset:33792
    s_cbranch_vccnz R_fh
B_fh:
    v_mfma_f32_32x32x16_bf16 v[64:79], v[204:207], v[144:147], v[64:79]
    ds_read_b64_tr_b16 v[228:229], v57 offset:36864
    ds_read_b64_tr_b16 v[230:231], v57 offset:37888
    s_waitcnt lgkmcnt(8)
    v_mfma_f32_32x32x16_bf16 v[80:95], v[208:211], v[144:147], v[80:95]
    ds_read_b64_tr_b16 v[200:201], v58 offset:36864
    ds_read_b64_tr_b16 v[202:203], v58 offset:37888
    buffer_load_dwordx4 v[244:247], v2, s[4:7], s37 offen offset:2048 sc1
    v_mfma_f32_32x32x16_bf16 v[96:111], v[212:215], v[144:147], v[96:111]
    ds_read_b64_tr_b16 v[204:205], v59 offset:36864
    ds_read_b64_tr_b16 v[206:207], v59 offset:37888
    buffer_load_dwordx4 v[248:251], v2, s[4:7], s38 offen offset:2048 sc1
    s_waitcnt vmcnt(11)
    v_bitop3_b32 v8, v152, v154, v0 bitop3:0x7e
    v_bitop3_b32 v9, v153, v155, v7 bitop3:0x7e
    v_bitop3_b32 v21, v156, v158, v0 bitop3:0x7e
    s_waitcnt lgkmcnt(8)
    v_mfma_f32_32x32x16_bf16 v[64:79], v[216:219], v[148:151], v[64:79]
    ds_read_b64_tr_b16 v[208:209], v61 offset:8192
    ds_read_b64_tr_b16 v[210:211], v61 offset:9216
    buffer_load_dwordx4 v[252:255], v2, s[4:7], s39 offen offset:2048 sc1
    v_or3_b32 v8, v8, v9, v21
    v_bitop3_b32 v9, v157, v159, v7 bitop3:0x7e
    v_bitop3_b32 v21, v160, v162, v0 bitop3:0x7e
    v_or3_b32 v8, v8, v9, v21
    v_mfma_f32_32x32x16_bf16 v[80:95], v[220:223], v[148:151], v[80:95]
    ds_read_b64_tr_b16 v[212:213], v61 offset:36864
    ds_read_b64_tr_b16 v[214:215], v61 offset:37888
    v_bitop3_b32 v9, v161, v163, v7 bitop3:0x7e
    v_bitop3_b32 v8, v8, v9, s48 bitop3:0xa8
    v_cmp_ne_u32 vcc, 0, v8
    s_waitcnt lgkmcnt(8)
    v_mfma_f32_32x32x16_bf16 v[96:111], v[224:227], v[148:151], v[96:111]
    ds_read_b64_tr_b16 v[216:217], v57 offset:40960
    ds_read_b64_tr_b16 v[218:219], v57 offset:41984
    s_cbranch_vccnz R_q2
B_q2:
    v_mfma_f32_32x32x16_bf16 v[64:79], v[228:231], v[152:155], v[64:79]
    ds_read_b64_tr_b16 v[220:221], v61 offset:12288
    ds_read_b64_tr_b16 v[222:223], v61 offset:13312
    s_waitcnt lgkmcnt(8)
    v_mfma_f32_32x32x16_bf16 v[80:95], v[200:203], v[152:155], v[80:95]
    ds_read_b64_tr_b16 v[224:225], v61 offset:40960
    ds_read_b64_tr_b16 v[226:227], v61 offset:41984
    s_waitcnt vmcnt(9)
    v_bitop3_b32 v8, v164, v166, v0 bitop3:0x7e
    v_bitop3_b32 v9, v165, v167, v7 bitop3:0x7e
    v_bitop3_b32 v21, v168, v170, v0 bitop3:0x7e
    v_mfma_f32_32x32x16_bf16 v[96:111], v[204:207], v[152:155], v[96:111]
    ds_read_b64_tr_b16 v[228:229], v57 offset:45056
    ds_read_b64_tr_b16 v[230:231], v57 offset:46080
    v_or3_b32 v8, v8, v9, v21
    v_bitop3_b32 v9, v169, v171, v7 bitop3:0x7e
    v_bitop3_b32 v21, v172, v174, v0 bitop3:0x7e
    v_or3_b32 v8, v8, v9, v21
    s_waitcnt lgkmcnt(8)
    v_mfma_f32_32x32x16_bf16 v[64:79], v[208:211], v[156:159], v[64:79]
    ds_read_b64_tr_b16 v[200:201], v61 offset:16384
    ds_read_b64_tr_b16 v[202:203], v61 offset:17408
    v_bitop3_b32 v9, v173, v175, v7 bitop3:0x7e
    v_bitop3_b32 v8, v8, v9, s48 bitop3:0xa8
    v_cmp_ne_u32 vcc, 0, v8
    v_mfma_f32_32x32x16_bf16 v[64:79], v[212:215], v[160:163], v[64:79]
    ds_read_b64_tr_b16 v[204:205], v61 offset:45056
    ds_read_b64_tr_b16 v[206:207], v61 offset:46080
    s_cbranch_vccnz R_q3
B_q3:
    s_waitcnt vmcnt(6)
    v_bitop3_b32 v8, v176, v178, v0 bitop3:0x7e
    v_bitop3_b32 v9, v177, v179, v7 bitop3:0x7e
    v_bitop3_b32 v21, v180, v182, v0 bitop3:0x7e
    s_waitcnt lgkmcnt(8)
    v_mfma_f32_32x32x16_bf16 v[64:79], v[216:219], v[164:167], v[64:79]
    ds_read_b64_tr_b16 v[208:209], v57 offset:49152
    ds_read_b64_tr_b16 v[210:211], v57 offset:50176
    v_or3_b32 v8, v8, v9, v21
    v_bitop3_b32 v9, v181, v183, v7 bitop3:0x7e
    v_bitop3_b32 v21, v184, v186, v0 bitop3:0x7e
    v_or3_b32 v8, v8, v9, v21
    v_mfma_f32_32x32x16_bf16 v[64:79], v[220:223], v[168:171], v[64:79]
    ds_read_b64_tr_b16 v[212:213], v61 offset:20480
    ds_read_b64_tr_b16 v[214:215], v61 offset:21504
    v_bitop3_b32 v9, v185, v187, v7 bitop3:0x7e
    v_bitop3_b32 v8, v8, v9, s48 bitop3:0xa8
    v_cmp_ne_u32 vcc, 0, v8
    s_waitcnt lgkmcnt(8)
    v_mfma_f32_32x32x16_bf16 v[64:79], v[224:227], v[172:175], v[64:79]
    ds_read_b64_tr_b16 v[216:217], v61 offset:49152
    ds_read_b64_tr_b16 v[218:219], v61 offset:50176
    s_cbranch_vccnz R_q4
B_q4:
    s_waitcnt vmcnt(3)
    v_bitop3_b32 v8, v188, v190, v0 bitop3:0x7e
    v_bitop3_b32 v9, v189, v191, v7 bitop3:0x7e
    v_bitop3_b32 v21, v192, v194, v0 bitop3:0x7e
    v_mfma_f32_32x32x16_bf16 v[64:79], v[228:231], v[176:179], v[64:79]
    ds_read_b64_tr_b16 v[220:221], v57 offset:53248
    ds_read_b64_tr_b16 v[222:223], v57 offset:54272
    v_or3_b32 v8, v8, v9, v21
    v_bitop3_b32 v9, v193, v195, v7 bitop3:0x7e
    v_bitop3_b32 v21, v196, v198, v0 bitop3:0x7e
    v_or3_b32 v8, v8, v9, v21
    s_waitcnt lgkmcnt(8)
    v_mfma_f32_32x32x16_bf16 v[64:79], v[200:203], v[180:183], v[64:79]
    ds_read_b64_tr_b16 v[224:225], v61 offset:24576
    ds_read_b64_tr_b16 v[226:227], v61 offset:25600
    v_bitop3_b32 v9, v197, v199, v7 bitop3:0x7e
    v_bitop3_b32 v8, v8, v9, s48 bitop3:0xa8
    v_cmp_ne_u32 vcc, 0, v8
    v_mfma_f32_32x32x16_bf16 v[64:79], v[204:207], v[184:187], v[64:79]
    ds_read_b64_tr_b16 v[228:229], v61 offset:53248
    ds_read_b64_tr_b16 v[230:231], v61 offset:54272
    s_cbranch_vccnz R_q5
B_q5:
    s_waitcnt vmcnt(0)
    v_bitop3_b32 v8, v244, v246, v0 bitop3:0x7e
    v_bitop3_b32 v9, v245, v247, v7 bitop3:0x7e
    v_bitop3_b32 v21, v248, v250, v0 bitop3:0x7e
    s_waitcnt lgkmcnt(8)
    v_mfma_f32_32x32x16_bf16 v[64:79], v[208:211], v[188:191], v[64:79]
    ds_read_b64_tr_b16 v[200:201], v62 offset:8192
    ds_read_b64_tr_b16 v[202:203], v62 offset:9216
    v_or3_b32 v8, v8, v9, v21
    v_bitop3_b32 v9, v249, v251, v7 bitop3:0x7e
    v_bitop3_b32 v21, v252, v254, v0 bitop3:0x7e
    v_or3_b32 v8, v8, v9, v21
    v_mfma_f32_32x32x16_bf16 v[64:79], v[212:215], v[192:195], v[64:79]
    ds_read_b64_tr_b16 v[204:205], v62 offset:36864
    ds_read_b64_tr_b16 v[206:207], v62 offset:37888
    v_bitop3_b32 v9, v253, v255, v7 bitop3:0x7e
    v_bitop3_b32 v8, v8, v9, s48 bitop3:0xa8
    v_cmp_ne_u32 vcc, 0, v8
    s_waitcnt lgkmcnt(8)
    v_mfma_f32_32x32x16_bf16 v[64:79], v[216:219], v[196:199], v[64:79]
    ds_read_b64_tr_b16 v[208:209], v58 offset:40960
    ds_read_b64_tr_b16 v[210:211], v58 offset:41984
    s_cbranch_vccnz R_q6
B_q6:
    v_mfma_f32_32x32x16_bf16 v[64:79], v[220:223], v[244:247], v[64:79]
    ds_read_b64_tr_b16 v[212:213], v62 offset:12288
    ds_read_b64_tr_b16 v[214:215], v62 offset:13312
    s_waitcnt lgkmcnt(8)
    v_mfma_f32_32x32x16_bf16 v[64:79], v[224:227], v[248:251], v[64:79]
    ds_read_b64_tr_b16 v[216:217], v62 offset:40960
    ds_read_b64_tr_b16 v[218:219], v62 offset:41984
    v_mfma_f32_32x32x16_bf16 v[64:79], v[228:231], v[252:255], v[64:79]
    ds_read_b64_tr_b16 v[220:221], v58 offset:45056
    ds_read_b64_tr_b16 v[222:223], v58 offset:46080
    s_waitcnt lgkmcnt(8)
    v_mfma_f32_32x32x16_bf16 v[80:95], v[200:203], v[156:159], v[80:95]
    ds_read_b64_tr_b16 v[224:225], v62 offset:16384
    ds_read_b64_tr_b16 v[226:227], v62 offset:17408
    v_mfma_f32_32x32x16_bf16 v[80:95], v[204:207], v[160:163], v[80:95]
    ds_read_b64_tr_b16 v[228:229], v62 offset:45056
    ds_read_b64_tr_b16 v[230:231], v62 offset:46080
    s_nop 2
    v_perm_b32 v232, v65, v64, s50
    v_perm_b32 v233, v67, v66, s50
    v_perm_b32 v234, v69, v68, s50
    v_perm_b32 v235, v71, v70, s50
    v_bfi_b32 v232, s48, v0, v232
    v_bfi_b32 v233, s48, v7, v233
    v_bfi_b32 v234, s48, v0, v234
    v_bfi_b32 v235, s48, v7, v235
    buffer_store_dwordx4 v[232:235], v3, s[4:7], s41 offen offset:0 sc1
    s_waitcnt lgkmcnt(8)
    v_mfma_f32_32x32x16_bf16 v[80:95], v[208:211], v[164:167], v[80:95]
    ds_read_b64_tr_b16 v[200:201], v58 offset:49152
    ds_read_b64_tr_b16 v[202:203], v58 offset:50176
    v_perm_b32 v236, v73, v72, s50
    v_perm_b32 v237, v75, v74, s50
    v_perm_b32 v238, v77, v76, s50
    v_perm_b32 v239, v79, v78, s50
    v_bfi_b32 v236, s48, v0, v236
    v_bfi_b32 v237, s48, v7, v237
    v_bfi_b32 v238, s48, v0, v238
    v_bfi_b32 v239, s48, v7, v239
    buffer_store_dwordx4 v[236:239], v3, s[4:7], s41 offen offset:1024 sc1
    v_mfma_f32_32x32x16_bf16 v[80:95], v[212:215], v[168:171], v[80:95]
    ds_read_b64_tr_b16 v[204:205], v62 offset:20480
    ds_read_b64_tr_b16 v[206:207], v62 offset:21504
    s_waitcnt lgkmcnt(8)
    v_mfma_f32_32x32x16_bf16 v[80:95], v[216:219], v[172:175], v[80:95]
    ds_read_b64_tr_b16 v[208:209], v62 offset:49152
    ds_read_b64_tr_b16 v[210:211], v62 offset:50176
    v_mfma_f32_32x32x16_bf16 v[80:95], v[220:223], v[176:179], v[80:95]
    ds_read_b64_tr_b16 v[212:213], v58 offset:53248
    ds_read_b64_tr_b16 v[214:215], v58 offset:54272
    s_waitcnt lgkmcnt(8)
    v_mfma_f32_32x32x16_bf16 v[80:95], v[224:227], v[180:183], v[80:95]
    ds_read_b64_tr_b16 v[216:217], v62 offset:24576
    ds_read_b64_tr_b16 v[218:219], v62 offset:25600
    v_mfma_f32_32x32x16_bf16 v[80:95], v[228:231], v[184:187], v[80:95]
    ds_read_b64_tr_b16 v[220:221], v62 offset:53248
    ds_read_b64_tr_b16 v[222:223], v62 offset:54272
    s_waitcnt lgkmcnt(8)
    v_mfma_f32_32x32x16_bf16 v[80:95], v[200:203], v[188:191], v[80:95]
    ds_read_b64_tr_b16 v[224:225], v63 offset:8192
    ds_read_b64_tr_b16 v[226:227], v63 offset:9216
    v_mfma_f32_32x32x16_bf16 v[80:95], v[204:207], v[192:195], v[80:95]
    ds_read_b64_tr_b16 v[228:229], v63 offset:36864
    ds_read_b64_tr_b16 v[230:231], v63 offset:37888
    s_waitcnt lgkmcnt(8)
    v_mfma_f32_32x32x16_bf16 v[80:95], v[208:211], v[196:199], v[80:95]
    ds_read_b64_tr_b16 v[200:201], v59 offset:40960
    ds_read_b64_tr_b16 v[202:203], v59 offset:41984
    v_mfma_f32_32x32x16_bf16 v[80:95], v[212:215], v[244:247], v[80:95]
    ds_read_b64_tr_b16 v[204:205], v63 offset:12288
    ds_read_b64_tr_b16 v[206:207], v63 offset:13312
    s_waitcnt lgkmcnt(8)
    v_mfma_f32_32x32x16_bf16 v[80:95], v[216:219], v[248:251], v[80:95]
    ds_read_b64_tr_b16 v[208:209], v63 offset:40960
    ds_read_b64_tr_b16 v[210:211], v63 offset:41984
    v_mfma_f32_32x32x16_bf16 v[80:95], v[220:223], v[252:255], v[80:95]
    ds_read_b64_tr_b16 v[212:213], v59 offset:45056
    ds_read_b64_tr_b16 v[214:215], v59 offset:46080
    s_waitcnt lgkmcnt(8)
    v_mfma_f32_32x32x16_bf16 v[96:111], v[224:227], v[156:159], v[96:111]
    ds_read_b64_tr_b16 v[216:217], v63 offset:16384
    ds_read_b64_tr_b16 v[218:219], v63 offset:17408
    v_mfma_f32_32x32x16_bf16 v[96:111], v[228:231], v[160:163], v[96:111]
    ds_read_b64_tr_b16 v[220:221], v63 offset:45056
    ds_read_b64_tr_b16 v[222:223], v63 offset:46080
    s_nop 2
    v_perm_b32 v232, v81, v80, s50
    v_perm_b32 v233, v83, v82, s50
    v_perm_b32 v234, v85, v84, s50
    v_perm_b32 v235, v87, v86, s50
    v_bfi_b32 v232, s48, v0, v232
    v_bfi_b32 v233, s48, v7, v233
    v_bfi_b32 v234, s48, v0, v234
    v_bfi_b32 v235, s48, v7, v235
    buffer_store_dwordx4 v[232:235], v3, s[4:7], s42 offen offset:0 sc1
    s_waitcnt lgkmcnt(8)
    v_mfma_f32_32x32x16_bf16 v[96:111], v[200:203], v[164:167], v[96:111]
    ds_read_b64_tr_b16 v[224:225], v59 offset:49152
    ds_read_b64_tr_b16 v[226:227], v59 offset:50176
    v_perm_b32 v236, v89, v88, s50
    v_perm_b32 v237, v91, v90, s50
    v_perm_b32 v238, v93, v92, s50
    v_perm_b32 v239, v95, v94, s50
    v_bfi_b32 v236, s48, v0, v236
    v_bfi_b32 v237, s48, v7, v237
    v_bfi_b32 v238, s48, v0, v238
    v_bfi_b32 v239, s48, v7, v239
    buffer_store_dwordx4 v[236:239], v3, s[4:7], s42 offen offset:1024 sc1
    v_mfma_f32_32x32x16_bf16 v[96:111], v[204:207], v[168:171], v[96:111]
    ds_read_b64_tr_b16 v[228:229], v63 offset:20480
    ds_read_b64_tr_b16 v[230:231], v63 offset:21504
    s_waitcnt lgkmcnt(8)
    v_mfma_f32_32x32x16_bf16 v[96:111], v[208:211], v[172:175], v[96:111]
    ds_read_b64_tr_b16 v[200:201], v63 offset:49152
    ds_read_b64_tr_b16 v[202:203], v63 offset:50176
    v_mfma_f32_32x32x16_bf16 v[96:111], v[212:215], v[176:179], v[96:111]
    ds_read_b64_tr_b16 v[204:205], v59 offset:53248
    ds_read_b64_tr_b16 v[206:207], v59 offset:54272
    s_waitcnt lgkmcnt(8)
    v_mfma_f32_32x32x16_bf16 v[96:111], v[216:219], v[180:183], v[96:111]
    ds_read_b64_tr_b16 v[208:209], v63 offset:24576
    ds_read_b64_tr_b16 v[210:211], v63 offset:25600
    v_mfma_f32_32x32x16_bf16 v[96:111], v[220:223], v[184:187], v[96:111]
    ds_read_b64_tr_b16 v[212:213], v63 offset:53248
    ds_read_b64_tr_b16 v[214:215], v63 offset:54272
    s_waitcnt lgkmcnt(8)
    v_mfma_f32_32x32x16_bf16 v[96:111], v[224:227], v[188:191], v[96:111]
    ds_read_b64_tr_b16 v[216:217], v56 offset:0
    ds_read_b64_tr_b16 v[218:219], v56 offset:1024
    v_mfma_f32_32x32x16_bf16 v[96:111], v[228:231], v[192:195], v[96:111]
    ds_read_b64_tr_b16 v[220:221], v56 offset:4096
    ds_read_b64_tr_b16 v[222:223], v56 offset:5120
    s_waitcnt lgkmcnt(8)
    v_mfma_f32_32x32x16_bf16 v[96:111], v[200:203], v[196:199], v[96:111]
    ds_read_b64_tr_b16 v[224:225], v56 offset:8192
    ds_read_b64_tr_b16 v[226:227], v56 offset:9216
    v_mfma_f32_32x32x16_bf16 v[96:111], v[204:207], v[244:247], v[96:111]
    ds_read_b64_tr_b16 v[228:229], v56 offset:12288
    ds_read_b64_tr_b16 v[230:231], v56 offset:13312
    s_waitcnt lgkmcnt(8)
    v_mfma_f32_32x32x16_bf16 v[96:111], v[208:211], v[248:251], v[96:111]
    ds_read_b64_tr_b16 v[200:201], v56 offset:16384
    ds_read_b64_tr_b16 v[202:203], v56 offset:17408
    v_mfma_f32_32x32x16_bf16 v[96:111], v[212:215], v[252:255], v[96:111]
    ds_read_b64_tr_b16 v[204:205], v56 offset:20480
    ds_read_b64_tr_b16 v[206:207], v56 offset:21504
    s_waitcnt lgkmcnt(8)
    v_mfma_f32_32x32x16_bf16 v[112:127], v[216:219], v[28:31], v[112:127]
    ds_read_b64_tr_b16 v[208:209], v56 offset:24576
    ds_read_b64_tr_b16 v[210:211], v56 offset:25600
    v_mfma_f32_32x32x16_bf16 v[112:127], v[220:223], v[32:35], v[112:127]
    ds_read_b64_tr_b16 v[212:213], v56 offset:28672
    ds_read_b64_tr_b16 v[214:215], v56 offset:29696
    s_nop 2
    v_perm_b32 v232, v97, v96, s50
    v_perm_b32 v233, v99, v98, s50
    v_perm_b32 v234, v101, v100, s50
    v_perm_b32 v235, v103, v102, s50
    v_bfi_b32 v232, s48, v0, v232
    v_bfi_b32 v233, s48, v7, v233
    v_bfi_b32 v234, s48, v0, v234
    v_bfi_b32 v235, s48, v7, v235
    buffer_store_dwordx4 v[232:235], v3, s[4:7], s43 offen offset:0 sc1
    s_waitcnt lgkmcnt(8)
    v_mfma_f32_32x32x16_bf16 v[112:127], v[224:227], v[36:39], v[112:127]
    ds_read_b64_tr_b16 v[216:217], v60 offset:0
    ds_read_b64_tr_b16 v[218:219], v60 offset:1024
    v_perm_b32 v236, v105, v104, s50
    v_perm_b32 v237, v107, v106, s50
    v_perm_b32 v238, v109, v108, s50
    v_perm_b32 v239, v111, v110, s50
    v_bfi_b32 v236, s48, v0, v236
    v_bfi_b32 v237, s48, v7, v237
    v_bfi_b32 v238, s48, v0, v238
    v_bfi_b32 v239, s48, v7, v239
    buffer_store_dwordx4 v[236:239], v3, s[4:7], s43 offen offset:1024 sc1
    v_mfma_f32_32x32x16_bf16 v[112:127], v[228:231], v[40:43], v[112:127]
    ds_read_b64_tr_b16 v[220:221], v60 offset:28672
    ds_read_b64_tr_b16 v[222:223], v60 offset:29696
    v_and_b32 v10, 15, v1
    v_lshlrev_b32 v10, 11, v10
    s_waitcnt lgkmcnt(8)
    v_mfma_f32_32x32x16_bf16 v[112:127], v[200:203], v[44:47], v[112:127]
    ds_read_b64_tr_b16 v[224:225], v56 offset:32768
    ds_read_b64_tr_b16 v[226:227], v56 offset:33792
    v_bfe_u32 v11, v1, 4, 1
    v_lshl_add_u32 v10, v11, 5, v10
    v_mfma_f32_32x32x16_bf16 v[112:127], v[204:207], v[48:51], v[112:127]
    ds_read_b64_tr_b16 v[228:229], v60 offset:4096
    ds_read_b64_tr_b16 v[230:231], v60 offset:5120
    v_lshrrev_b32 v11, 5, v1
    v_lshl_add_u32 v4, v11, 4, v10
    s_waitcnt lgkmcnt(8)
    v_mfma_f32_32x32x16_bf16 v[112:127], v[208:211], v[52:55], v[112:127]
    ds_read_b64_tr_b16 v[200:201], v60 offset:32768
    ds_read_b64_tr_b16 v[202:203], v60 offset:33792
    v_mfma_f32_32x32x16_bf16 v[112:127], v[212:215], v[128:131], v[112:127]
    ds_read_b64_tr_b16 v[204:205], v56 offset:36864
    ds_read_b64_tr_b16 v[206:207], v56 offset:37888
    s_waitcnt lgkmcnt(8)
    v_mfma_f32_32x32x16_bf16 v[112:127], v[216:219], v[132:135], v[112:127]
    s_branch S_3o
S_3:
    s_branch S_back
S_3o:
    ds_read_b64_tr_b16 v[208:209], v60 offset:8192
    ds_read_b64_tr_b16 v[210:211], v60 offset:9216
    v_mfma_f32_32x32x16_bf16 v[112:127], v[220:223], v[136:139], v[112:127]
    ds_read_b64_tr_b16 v[212:213], v60 offset:36864
    ds_read_b64_tr_b16 v[214:215], v60 offset:37888
    s_waitcnt lgkmcnt(8)
    v_mfma_f32_32x32x16_bf16 v[112:127], v[224:227], v[140:143], v[112:127]
    ds_read_b64_tr_b16 v[216:217], v56 offset:40960
    ds_read_b64_tr_b16 v[218:219], v56 offset:41984
    v_mfma_f32_32x32x16_bf16 v[112:127], v[228:231], v[144:147], v[112:127]
    ds_read_b64_tr_b16 v[220:221], v60 offset:12288
    ds_read_b64_tr_b16 v[222:223], v60 offset:13312
    s_waitcnt lgkmcnt(8)
    v_mfma_f32_32x32x16_bf16 v[112:127], v[200:203], v[148:151], v[112:127]
    ds_read_b64_tr_b16 v[224:225], v60 offset:40960
    ds_read_b64_tr_b16 v[226:227], v60 offset:41984
    v_mfma_f32_32x32x16_bf16 v[112:127], v[204:207], v[152:155], v[112:127]
    ds_read_b64_tr_b16 v[228:229], v56 offset:45056
    ds_read_b64_tr_b16 v[230:231], v56 offset:46080
    s_waitcnt lgkmcnt(8)
    v_mfma_f32_32x32x16_bf16 v[112:127], v[208:211], v[156:159], v[112:127]
    ds_read_b64_tr_b16 v[200:201], v60 offset:16384
    ds_read_b64_tr_b16 v[202:203], v60 offset:17408
    v_mfma_f32_32x32x16_bf16 v[112:127], v[212:215], v[160:163], v[112:127]
    ds_read_b64_tr_b16 v[204:205], v60 offset:45056
    ds_read_b64_tr_b16 v[206:207], v60 offset:46080
    s_waitcnt lgkmcnt(8)
    v_mfma_f32_32x32x16_bf16 v[112:127], v[216:219], v[164:167], v[112:127]
    ds_read_b64_tr_b16 v[208:209], v56 offset:49152
    ds_read_b64_tr_b16 v[210:211], v56 offset:50176
    v_mfma_f32_32x32x16_bf16 v[112:127], v[220:223], v[168:171], v[112:127]
    ds_read_b64_tr_b16 v[212:213], v60 offset:20480
    ds_read_b64_tr_b16 v[214:215], v60 offset:21504
    s_waitcnt lgkmcnt(8)
    v_mfma_f32_32x32x16_bf16 v[112:127], v[224:227], v[172:175], v[112:127]
    ds_read_b64_tr_b16 v[216:217], v60 offset:49152
    ds_read_b64_tr_b16 v[218:219], v60 offset:50176
    v_mfma_f32_32x32x16_bf16 v[112:127], v[228:231], v[176:179], v[112:127]
    ds_read_b64_tr_b16 v[220:221], v56 offset:53248
    ds_read_b64_tr_b16 v[222:223], v56 offset:54272
    s_waitcnt lgkmcnt(8)
    v_mfma_f32_32x32x16_bf16 v[112:127], v[200:203], v[180:183], v[112:127]
    ds_read_b64_tr_b16 v[224:225], v60 offset:24576
    ds_read_b64_tr_b16 v[226:227], v60 offset:25600
    v_mfma_f32_32x32x16_bf16 v[112:127], v[204:207], v[184:187], v[112:127]
    ds_read_b64_tr_b16 v[228:229], v60 offset:53248
    ds_read_b64_tr_b16 v[230:231], v60 offset:54272
    s_waitcnt lgkmcnt(8)
    v_mfma_f32_32x32x16_bf16 v[112:127], v[208:211], v[188:191], v[112:127]
    v_mfma_f32_32x32x16_bf16 v[112:127], v[212:215], v[192:195], v[112:127]
    s_waitcnt lgkmcnt(4)
    v_mfma_f32_32x32x16_bf16 v[112:127], v[216:219], v[196:199], v[112:127]
    v_mfma_f32_32x32x16_bf16 v[112:127], v[220:223], v[244:247], v[112:127]
    s_waitcnt lgkmcnt(0)
    v_mfma_f32_32x32x16_bf16 v[112:127], v[224:227], v[248:251], v[112:127]
    v_mfma_f32_32x32x16_bf16 v[112:127], v[228:231], v[252:255], v[112:127]
    buffer_load_dwordx4 v[64:67], v3, s[4:7], s44 offen offset:0 sc1
    buffer_load_dwordx4 v[68:71], v3, s[4:7], s44 offen offset:1024 sc1
    buffer_load_dwordx4 v[80:83], v3, s[4:7], s45 offen offset:0 sc1
    buffer_load_dwordx4 v[84:87], v3, s[4:7], s45 offen offset:1024 sc1
    buffer_load_dwordx4 v[96:99], v3, s[4:7], s46 offen offset:0 sc1
    buffer_load_dwordx4 v[100:103], v3, s[4:7], s46 offen offset:1024 sc1
    s_waitcnt vmcnt(4)
    v_bitop3_b32 v8, v64, v66, v0 bitop3:0x7e
    v_bitop3_b32 v9, v65, v67, v7 bitop3:0x7e
    v_bitop3_b32 v21, v68, v70, v0 bitop3:0x7e
    v_or3_b32 v8, v8, v9, v21
    v_bitop3_b32 v9, v69, v71, v7 bitop3:0x7e
    v_bitop3_b32 v8, v8, v9, s48 bitop3:0xa8
    v_cmp_ne_u32 vcc, 0, v8
    s_cbranch_vccnz R_r1
B_r1:
    v_lshl_or_b32 v200, v64, 16, s49
    v_and_or_b32 v201, v64, v13, s49
    v_lshl_or_b32 v202, v65, 16, s49
    v_and_or_b32 v203, v65, v13, s49
    v_lshl_or_b32 v204, v66, 16, s49
    v_and_or_b32 v205, v66, v13, s49
    v_lshl_or_b32 v206, v67, 16, s49
    v_and_or_b32 v207, v67, v13, s49
    v_lshl_or_b32 v208, v68, 16, s49
    v_and_or_b32 v209, v68, v13, s49
    v_lshl_or_b32 v210, v69, 16, s49
    v_and_or_b32 v211, v69, v13, s49
    v_lshl_or_b32 v212, v70, 16, s49
    v_and_or_b32 v213, v70, v13, s49
    v_lshl_or_b32 v214, v71, 16, s49
    v_and_or_b32 v215, v71, v13, s49
    v_pk_add_f32 v[112:113], v[112:113], v[200:201]
    v_pk_add_f32 v[114:115], v[114:115], v[202:203]
    v_pk_add_f32 v[116:117], v[116:117], v[204:205]
    v_pk_add_f32 v[118:119], v[118:119], v[206:207]
    v_pk_add_f32 v[120:121], v[120:121], v[208:209]
    v_pk_add_f32 v[122:123], v[122:123], v[210:211]
    v_pk_add_f32 v[124:125], v[124:125], v[212:213]
    v_pk_add_f32 v[126:127], v[126:127], v[214:215]
    s_waitcnt vmcnt(2)
    v_bitop3_b32 v8, v80, v82, v0 bitop3:0x7e
    v_bitop3_b32 v9, v81, v83, v7 bitop3:0x7e
    v_bitop3_b32 v21, v84, v86, v0 bitop3:0x7e
    v_or3_b32 v8, v8, v9, v21
    v_bitop3_b32 v9, v85, v87, v7 bitop3:0x7e
    v_bitop3_b32 v8, v8, v9, s48 bitop3:0xa8
    v_cmp_ne_u32 vcc, 0, v8
    s_cbranch_vccnz R_r2
B_r2:
    v_lshl_or_b32 v200, v80, 16, s49
    v_and_or_b32 v201, v80, v13, s49
    v_lshl_or_b32 v202, v81, 16, s49
    v_and_or_b32 v203, v81, v13, s49
    v_lshl_or_b32 v204, v82, 16, s49
    v_and_or_b32 v205, v82, v13, s49
    v_lshl_or_b32 v206, v83, 16, s49
    v_and_or_b32 v207, v83, v13, s49
    v_lshl_or_b32 v208, v84, 16, s49
    v_and_or_b32 v209, v84, v13, s49
    v_lshl_or_b32 v210, v85, 16, s49
    v_and_or_b32 v211, v85, v13, s49
    v_lshl_or_b32 v212, v86, 16, s49
    v_and_or_b32 v213, v86, v13, s49
    v_lshl_or_b32 v214, v87, 16, s49
    v_and_or_b32 v215, v87, v13, s49
    v_pk_add_f32 v[112:113], v[112:113], v[200:201]
    v_pk_add_f32 v[114:115], v[114:115], v[202:203]
    v_pk_add_f32 v[116:117], v[116:117], v[204:205]
    v_pk_add_f32 v[118:119], v[118:119], v[206:207]
    v_pk_add_f32 v[120:121], v[120:121], v[208:209]
    v_pk_add_f32 v[122:123], v[122:123], v[210:211]
    v_pk_add_f32 v[124:125], v[124:125], v[212:213]
    v_pk_add_f32 v[126:127], v[126:127], v[214:215]
    s_waitcnt vmcnt(0)
    v_bitop3_b32 v8, v96, v98, v0 bitop3:0x7e
    v_bitop3_b32 v9, v97, v99, v7 bitop3:0x7e
    v_bitop3_b32 v21, v100, v102, v0 bitop3:0x7e
    v_or3_b32 v8, v8, v9, v21
    v_bitop3_b32 v9, v101, v103, v7 bitop3:0x7e
    v_bitop3_b32 v8, v8, v9, s48 bitop3:0xa8
    v_cmp_ne_u32 vcc, 0, v8
    s_cbranch_vccnz R_r3
B_r3:
    v_lshl_or_b32 v200, v96, 16, s49
    v_and_or_b32 v201, v96, v13, s49
    v_lshl_or_b32 v202, v97, 16, s49
    v_and_or_b32 v203, v97, v13, s49
    v_lshl_or_b32 v204, v98, 16, s49
    v_and_or_b32 v205, v98, v13, s49
    v_lshl_or_b32 v206, v99, 16, s49
    v_and_or_b32 v207, v99, v13, s49
    v_lshl_or_b32 v208, v100, 16, s49
    v_and_or_b32 v209, v100, v13, s49
    v_lshl_or_b32 v210, v101, 16, s49
    v_and_or_b32 v211, v101, v13, s49
    v_lshl_or_b32 v212, v102, 16, s49
    v_and_or_b32 v213, v102, v13, s49
    v_lshl_or_b32 v214, v103, 16, s49
    v_and_or_b32 v215, v103, v13, s49
    v_pk_add_f32 v[112:113], v[112:113], v[200:201]
    v_pk_add_f32 v[114:115], v[114:115], v[202:203]
    v_pk_add_f32 v[116:117], v[116:117], v[204:205]
    v_pk_add_f32 v[118:119], v[118:119], v[206:207]
    v_pk_add_f32 v[120:121], v[120:121], v[208:209]
    v_pk_add_f32 v[122:123], v[122:123], v[210:211]
    v_pk_add_f32 v[124:125], v[124:125], v[212:213]
    v_pk_add_f32 v[126:127], v[126:127], v[214:215]
    v_cvt_pk_bf16_f32 v224, v112, v113
    v_cvt_pk_bf16_f32 v228, v120, v121
    v_cvt_pk_bf16_f32 v225, v114, v115
    v_cvt_pk_bf16_f32 v229, v122, v123
    v_cvt_pk_bf16_f32 v226, v116, v117
    v_cvt_pk_bf16_f32 v230, v124, v125
    v_cvt_pk_bf16_f32 v227, v118, v119
    v_cvt_pk_bf16_f32 v231, v126, v127
    v_permlane16_swap_b32 v224, v228
    v_permlane16_swap_b32 v225, v229
    v_permlane16_swap_b32 v226, v230
    v_permlane16_swap_b32 v227, v231
    buffer_store_dwordx4 v[224:227], v4, s[20:23], s47 offen offset:0 nt
    buffer_store_dwordx4 v[228:231], v4, s[20:23], s47 offen offset:1024 nt
L_endM:
    s_endpgm
R_h0:
    s_sub_u32 s28, s28, 1
    s_cbranch_scc1 X_h0
    buffer_load_dwordx2 v[64:65], v22, s[4:7], s8 offen offset:0 sc1
    buffer_load_dwordx2 v[66:67], v22, s[4:7], s8 offen offset:128 sc1
    buffer_load_dwordx2 v[68:69], v22, s[4:7], s8 offen offset:512 sc1
    buffer_load_dwordx2 v[70:71], v22, s[4:7], s8 offen offset:640 sc1
    s_waitcnt vmcnt(0)
    v_max3_f32 v8, |v65|, |v67|, |v69|
    v_max_f32_e64 v8, |v71|, v8
    v_cmp_le_f32 vcc, s52, v8
    s_cbranch_vccnz R_h0
    s_branch B_h0
X_h0:
    s_mov_b32 s28, 0
    s_branch B_h0
R_st:
    ds_read_b32 v9, v20 offset:48
    ds_read2_b64 v[10:13], v25 offset0:16 offset1:34
    ds_read_b128 v[184:187], v24
    ds_read_b128 v[188:191], v24 offset:512
    s_waitcnt lgkmcnt(0)
    v_cmp_eq_u32 vcc, 0, v9
    s_cbranch_vccnz R_st
    s_branch B_st
R_h1:
    s_sub_u32 s28, s28, 1
    s_cbranch_scc1 X_h1
    buffer_load_dwordx2 v[72:73], v22, s[4:7], s8 offen offset:2048 sc1
    buffer_load_dwordx2 v[74:75], v22, s[4:7], s8 offen offset:2176 sc1
    buffer_load_dwordx2 v[76:77], v22, s[4:7], s8 offen offset:2560 sc1
    buffer_load_dwordx2 v[78:79], v22, s[4:7], s8 offen offset:2688 sc1
    s_waitcnt vmcnt(0)
    v_max3_f32 v8, |v73|, |v75|, |v77|
    v_max_f32_e64 v8, |v79|, v8
    v_cmp_le_f32 vcc, s52, v8
    s_cbranch_vccnz R_h1
    s_branch B_h1
X_h1:
    s_mov_b32 s28, 0
    s_branch B_h1
R_h2:
    s_sub_u32 s28, s28, 1
    s_cbranch_scc1 X_h2
    buffer_load_dwordx2 v[80:81], v23, s[4:7], s8 offen offset:0 sc1
    buffer_load_dwordx2 v[82:83], v23, s[4:7], s8 offen offset:128 sc1
    buffer_load_dwordx2 v[84:85], v23, s[4:7], s8 offen offset:512 sc1
    buffer_load_dwordx2 v[86:87], v23, s[4:7], s8 offen offset:640 sc1
    s_waitcnt vmcnt(0)
    v_max3_f32 v8, |v81|, |v83|, |v85|
    v_max_f32_e64 v8, |v87|, v8
    v_cmp_le_f32 vcc, s52, v8
    s_cbranch_vccnz R_h2
    s_branch B_h2
X_h2:
    s_mov_b32 s28, 0
    s_branch B_h2
R_h3:
    s_sub_u32 s28, s28, 1
    s_cbranch_scc1 X_h3
    buffer_load_dwordx2 v[88:89], v23, s[4:7], s8 offen offset:2048 sc1
    buffer_load_dwordx2 v[90:91], v23, s[4:7], s8 offen offset:2176 sc1
    buffer_load_dwordx2 v[92:93], v23, s[4:7], s8 offen offset:2560 sc1
    buffer_load_dwordx2 v[94:95], v23, s[4:7], s8 offen offset:2688 sc1
    s_waitcnt vmcnt(0)
    v_max3_f32 v8, |v89|, |v91|, |v93|
    v_max_f32_e64 v8, |v95|, v8
    v_cmp_le_f32 vcc, s52, v8
    s_cbranch_vccnz R_h3
    s_branch B_h3
X_h3:
    s_mov_b32 s28, 0
    s_branch B_h3
R_h12:
    s_sub_u32 s28, s28, 1
    s_cbranch_scc1 X_h12
    buffer_load_dwordx2 v[96:97], v22, s[4:7], s11 offen offset:0 sc1
    buffer_load_dwordx2 v[98:99], v22, s[4:7], s11 offen offset:128 sc1
    buffer_load_dwordx2 v[100:101], v22, s[4:7], s11 offen offset:512 sc1
    buffer_load_dwordx2 v[102:103], v22, s[4:7], s11 offen offset:640 sc1
    s_waitcnt vmcnt(0)
    v_max3_f32 v8, |v97|, |v99|, |v101|
    v_max_f32_e64 v8, |v103|, v8
    v_cmp_le_f32 vcc, s52, v8
    s_cbranch_vccnz R_h12
    s_branch B_h12
X_h12:
    s_mov_b32 s28, 0
    s_branch B_h12
R_h13:
    s_sub_u32 s28, s28, 1
    s_cbranch_scc1 X_h13
    buffer_load_dwordx2 v[104:105], v22, s[4:7], s11 offen offset:2048 sc1
    buffer_load_dwordx2 v[106:107], v22, s[4:7], s11 offen offset:2176 sc1
    buffer_load_dwordx2 v[108:109], v22, s[4:7], s11 offen offset:2560 sc1
    buffer_load_dwordx2 v[110:111], v22, s[4:7], s11 offen offset:2688 sc1
    s_waitcnt vmcnt(0)
    v_max3_f32 v8, |v105|, |v107|, |v109|
    v_max_f32_e64 v8, |v111|, v8
    v_cmp_le_f32 vcc, s52, v8
    s_cbranch_vccnz R_h13
    s_branch B_h13
X_h13:
    s_mov_b32 s28, 0
    s_branch B_h13
R_h14:
    s_sub_u32 s28, s28, 1
    s_cbranch_scc1 X_h14
    buffer_load_dwordx2 v[112:113], v23, s[4:7], s11 offen offset:0 sc1
    buffer_load_dwordx2 v[114:115], v23, s[4:7], s11 offen offset:128 sc1
    buffer_load_dwordx2 v[116:117], v23, s[4:7], s11 offen offset:512 sc1
    buffer_load_dwordx2 v[118:119], v23, s[4:7], s11 offen offset:640 sc1
    s_waitcnt vmcnt(0)
    v_max3_f32 v8, |v113|, |v115|, |v117|
    v_max_f32_e64 v8, |v119|, v8
    v_cmp_le_f32 vcc, s52, v8
    s_cbranch_vccnz R_h14
    s_branch B_h14
X_h14:
    s_mov_b32 s28, 0
    s_branch B_h14
R_h15:
    s_sub_u32 s28, s28, 1
    s_cbranch_scc1 X_h15
    buffer_load_dwordx2 v[120:121], v23, s[4:7], s11 offen offset:2048 sc1
    buffer_load_dwordx2 v[122:123], v23, s[4:7], s11 offen offset:2176 sc1
    buffer_load_dwordx2 v[124:125], v23, s[4:7], s11 offen offset:2560 sc1
    buffer_load_dwordx2 v[126:127], v23, s[4:7], s11 offen offset:2688 sc1
    s_waitcnt vmcnt(0)
    v_max3_f32 v8, |v121|, |v123|, |v125|
    v_max_f32_e64 v8, |v127|, v8
    v_cmp_le_f32 vcc, s52, v8
    s_cbranch_vccnz R_h15
    s_branch B_h15
X_h15:
    s_mov_b32 s28, 0
    s_branch B_h15
R_q6:
    s_sub_u32 s28, s28, 1
    s_cbranch_scc1 X_q6
    buffer_load_dwordx4 v[244:247], v2, s[4:7], s37 offen offset:2048 sc1
    buffer_load_dwordx4 v[248:251], v2, s[4:7], s38 offen offset:2048 sc1
    buffer_load_dwordx4 v[252:255], v2, s[4:7], s39 offen offset:2048 sc1
    s_waitcnt vmcnt(0)
    v_bitop3_b32 v8, v244, v246, v0 bitop3:0x7e
    v_bitop3_b32 v9, v245, v247, v7 bitop3:0x7e
    v_bitop3_b32 v21, v248, v250, v0 bitop3:0x7e
    v_or3_b32 v8, v8, v9, v21
    v_bitop3_b32 v9, v249, v251, v7 bitop3:0x7e
    v_bitop3_b32 v21, v252, v254, v0 bitop3:0x7e
    v_or3_b32 v8, v8, v9, v21
    v_bitop3_b32 v9, v253, v255, v7 bitop3:0x7e
    v_bitop3_b32 v8, v8, v9, s48 bitop3:0xa8
    v_cmp_ne_u32 vcc, 0, v8
    s_cbranch_vccnz R_q6
    s_branch B_q6
X_q6:
    s_mov_b32 s28, 0
    s_branch B_q6
R_q5:
    s_sub_u32 s28, s28, 1
    s_cbranch_scc1 X_q5
    buffer_load_dwordx4 v[188:191], v2, s[4:7], s37 offen offset:1024 sc1
    buffer_load_dwordx4 v[192:195], v2, s[4:7], s38 offen offset:1024 sc1
    buffer_load_dwordx4 v[196:199], v2, s[4:7], s39 offen offset:1024 sc1
    s_waitcnt vmcnt(0)
    v_bitop3_b32 v8, v188, v190, v0 bitop3:0x7e
    v_bitop3_b32 v9, v189, v191, v7 bitop3:0x7e
    v_bitop3_b32 v21, v192, v194, v0 bitop3:0x7e
    v_or3_b32 v8, v8, v9, v21
    v_bitop3_b32 v9, v193, v195, v7 bitop3:0x7e
    v_bitop3_b32 v21, v196, v198, v0 bitop3:0x7e
    v_or3_b32 v8, v8, v9, v21
    v_bitop3_b32 v9, v197, v199, v7 bitop3:0x7e
    v_bitop3_b32 v8, v8, v9, s48 bitop3:0xa8
    v_cmp_ne_u32 vcc, 0, v8
    s_cbranch_vccnz R_q5
    s_branch B_q5
X_q5:
    s_mov_b32 s28, 0
    s_branch B_q5
R_q4:
    s_sub_u32 s28, s28, 1
    s_cbranch_scc1 X_q4
    buffer_load_dwordx4 v[176:179], v2, s[4:7], s37 offen offset:0 sc1
    buffer_load_dwordx4 v[180:183], v2, s[4:7], s38 offen offset:0 sc1
    buffer_load_dwordx4 v[184:187], v2, s[4:7], s39 offen offset:0 sc1
    s_waitcnt vmcnt(0)
    v_bitop3_b32 v8, v176, v178, v0 bitop3:0x7e
    v_bitop3_b32 v9, v177, v179, v7 bitop3:0x7e
    v_bitop3_b32 v21, v180, v182, v0 bitop3:0x7e
    v_or3_b32 v8, v8, v9, v21
    v_bitop3_b32 v9, v181, v183, v7 bitop3:0x7e
    v_bitop3_b32 v21, v184, v186, v0 bitop3:0x7e
    v_or3_b32 v8, v8, v9, v21
    v_bitop3_b32 v9, v185, v187, v7 bitop3:0x7e
    v_bitop3_b32 v8, v8, v9, s48 bitop3:0xa8
    v_cmp_ne_u32 vcc, 0, v8
    s_cbranch_vccnz R_q4
    s_branch B_q4
X_q4:
    s_mov_b32 s28, 0
    s_branch B_q4
R_q3:
    s_sub_u32 s28, s28, 1
    s_cbranch_scc1 X_q3
    buffer_load_dwordx4 v[164:167], v3, s[4:7], s37 offen offset:3072 sc1
    buffer_load_dwordx4 v[168:171], v3, s[4:7], s38 offen offset:3072 sc1
    buffer_load_dwordx4 v[172:175], v3, s[4:7], s39 offen offset:3072 sc1
    s_waitcnt vmcnt(0)
    v_bitop3_b32 v8, v164, v166, v0 bitop3:0x7e
    v_bitop3_b32 v9, v165, v167, v7 bitop3:0x7e
    v_bitop3_b32 v21, v168, v170, v0 bitop3:0x7e
    v_or3_b32 v8, v8, v9, v21
    v_bitop3_b32 v9, v169, v171, v7 bitop3:0x7e
    v_bitop3_b32 v21, v172, v174, v0 bitop3:0x7e
    v_or3_b32 v8, v8, v9, v21
    v_bitop3_b32 v9, v173, v175, v7 bitop3:0x7e
    v_bitop3_b32 v8, v8, v9, s48 bitop3:0xa8
    v_cmp_ne_u32 vcc, 0, v8
    s_cbranch_vccnz R_q3
    s_branch B_q3
X_q3:
    s_mov_b32 s28, 0
    s_branch B_q3
R_q2:
    s_sub_u32 s28, s28, 1
    s_cbranch_scc1 X_q2
    buffer_load_dwordx4 v[152:155], v3, s[4:7], s37 offen offset:2048 sc1
    buffer_load_dwordx4 v[156:159], v3, s[4:7], s38 offen offset:2048 sc1
    buffer_load_dwordx4 v[160:163], v3, s[4:7], s39 offen offset:2048 sc1
    s_waitcnt vmcnt(0)
    v_bitop3_b32 v8, v152, v154, v0 bitop3:0x7e
    v_bitop3_b32 v9, v153, v155, v7 bitop3:0x7e
    v_bitop3_b32 v21, v156, v158, v0 bitop3:0x7e
    v_or3_b32 v8, v8, v9, v21
    v_bitop3_b32 v9, v157, v159, v7 bitop3:0x7e
    v_bitop3_b32 v21, v160, v162, v0 bitop3:0x7e
    v_or3_b32 v8, v8, v9, v21
    v_bitop3_b32 v9, v161, v163, v7 bitop3:0x7e
    v_bitop3_b32 v8, v8, v9, s48 bitop3:0xa8
    v_cmp_ne_u32 vcc, 0, v8
    s_cbranch_vccnz R_q2
    s_branch B_q2
X_q2:
    s_mov_b32 s28, 0
    s_branch B_q2
R_q1:
    s_sub_u32 s28, s28, 1
    s_cbranch_scc1 X_q1
    buffer_load_dwordx4 v[140:143], v3, s[4:7], s37 offen offset:1024 sc1
    buffer_load_dwordx4 v[144:147], v3, s[4:7], s38 offen offset:1024 sc1
    buffer_load_dwordx4 v[148:151], v3, s[4:7], s39 offen offset:1024 sc1
    s_waitcnt vmcnt(0)
    v_bitop3_b32 v8, v140, v142, v0 bitop3:0x7e
    v_bitop3_b32 v9, v141, v143, v7 bitop3:0x7e
    v_bitop3_b32 v21, v144, v146, v0 bitop3:0x7e
    v_or3_b32 v8, v8, v9, v21
    v_bitop3_b32 v9, v145, v147, v7 bitop3:0x7e
    v_bitop3_b32 v21, v148, v150, v0 bitop3:0x7e
    v_or3_b32 v8, v8, v9, v21
    v_bitop3_b32 v9, v149, v151, v7 bitop3:0x7e
    v_bitop3_b32 v8, v8, v9, s48 bitop3:0xa8
    v_cmp_ne_u32 vcc, 0, v8
    s_cbranch_vccnz R_q1
    s_branch B_q1
X_q1:
    s_mov_b32 s28, 0
    s_branch B_q1
R_q0:
    s_sub_u32 s28, s28, 1
    s_cbranch_scc1 X_q0
    buffer_load_dwordx4 v[128:131], v3, s[4:7], s37 offen offset:0 sc1
    buffer_load_dwordx4 v[132:135], v3, s[4:7], s38 offen offset:0 sc1
    buffer_load_dwordx4 v[136:139], v3, s[4:7], s39 offen offset:0 sc1
    s_waitcnt vmcnt(0)
    v_bitop3_b32 v8, v128, v130, v0 bitop3:0x7e
    v_bitop3_b32 v9, v129, v131, v7 bitop3:0x7e
    v_bitop3_b32 v21, v132, v134, v0 bitop3:0x7e
    v_or3_b32 v8, v8, v9, v21
    v_bitop3_b32 v9, v133, v135, v7 bitop3:0x7e
    v_bitop3_b32 v21, v136, v138, v0 bitop3:0x7e
    v_or3_b32 v8, v8, v9, v21
    v_bitop3_b32 v9, v137, v139, v7 bitop3:0x7e
    v_bitop3_b32 v8, v8, v9, s48 bitop3:0xa8
    v_cmp_ne_u32 vcc, 0, v8
    s_cbranch_vccnz R_q0
    s_branch B_q0
X_q0:
    s_mov_b32 s28, 0
    s_branch B_q0
R_r1:
    s_sub_u32 s28, s28, 1
    s_cbranch_scc1 X_r1
    buffer_load_dwordx4 v[64:67], v3, s[4:7], s44 offen offset:0 sc1
    buffer_load_dwordx4 v[68:71], v3, s[4:7], s44 offen offset:1024 sc1
    s_waitcnt vmcnt(0)
    v_bitop3_b32 v8, v64, v66, v0 bitop3:0x7e
    v_bitop3_b32 v9, v65, v67, v7 bitop3:0x7e
    v_bitop3_b32 v21, v68, v70, v0 bitop3:0x7e
    v_or3_b32 v8, v8, v9, v21
    v_bitop3_b32 v9, v69, v71, v7 bitop3:0x7e
    v_bitop3_b32 v8, v8, v9, s48 bitop3:0xa8
    v_cmp_ne_u32 vcc, 0, v8
    s_cbranch_vccnz R_r1
    s_branch B_r1
X_r1:
    s_mov_b32 s28, 0
    s_branch B_r1
R_r2:
    s_sub_u32 s28, s28, 1
    s_cbranch_scc1 X_r2
    buffer_load_dwordx4 v[80:83], v3, s[4:7], s45 offen offset:0 sc1
    buffer_load_dwordx4 v[84:87], v3, s[4:7], s45 offen offset:1024 sc1
    s_waitcnt vmcnt(0)
    v_bitop3_b32 v8, v80, v82, v0 bitop3:0x7e
    v_bitop3_b32 v9, v81, v83, v7 bitop3:0x7e
    v_bitop3_b32 v21, v84, v86, v0 bitop3:0x7e
    v_or3_b32 v8, v8, v9, v21
    v_bitop3_b32 v9, v85, v87, v7 bitop3:0x7e
    v_bitop3_b32 v8, v8, v9, s48 bitop3:0xa8
    v_cmp_ne_u32 vcc, 0, v8
    s_cbranch_vccnz R_r2
    s_branch B_r2
X_r2:
    s_mov_b32 s28, 0
    s_branch B_r2
R_r3:
    s_sub_u32 s28, s28, 1
    s_cbranch_scc1 X_r3
    buffer_load_dwordx4 v[96:99], v3, s[4:7], s46 offen offset:0 sc1
    buffer_load_dwordx4 v[100:103], v3, s[4:7], s46 offen offset:1024 sc1
    s_waitcnt vmcnt(0)
    v_bitop3_b32 v8, v96, v98, v0 bitop3:0x7e
    v_bitop3_b32 v9, v97, v99, v7 bitop3:0x7e
    v_bitop3_b32 v21, v100, v102, v0 bitop3:0x7e
    v_or3_b32 v8, v8, v9, v21
    v_bitop3_b32 v9, v101, v103, v7 bitop3:0x7e
    v_bitop3_b32 v8, v8, v9, s48 bitop3:0xa8
    v_cmp_ne_u32 vcc, 0, v8
    s_cbranch_vccnz R_r3
    s_branch B_r3
X_r3:
    s_mov_b32 s28, 0
    s_branch B_r3
R_fg:
    ds_read_b32 v9, v26
    s_waitcnt lgkmcnt(0)
    v_cmp_eq_u32 vcc, 0, v9
    s_cbranch_vccnz R_fg
    s_branch B_fg
R_fh:
    ds_read_b32 v6, v26
    s_waitcnt lgkmcnt(0)
    v_cmp_ne_u32 vcc, -1, v6
    s_cbranch_vccnz R_fh
    s_branch B_fh
L_code_end:
    s_endpgm
.section .rodata,"a"
.p2align 6
.amdhsa_kernel sequential_preLN__ssm_conv_s4d__mixer_channel_mlp__prompt_kernel
  .amdhsa_next_free_vgpr 256
  .amdhsa_next_free_sgpr 102
  .amdhsa_accum_offset 256
  .amdhsa_group_segment_fixed_size 0
  .amdhsa_kernarg_size 120
  .amdhsa_user_sgpr_count 2
  .amdhsa_user_sgpr_kernarg_segment_ptr 1
  .amdhsa_system_sgpr_workgroup_id_x 1
.end_amdhsa_kernel
```
